```python
import torch

def _softmax(x, axis=-1):
    return torch.softmax(x, dim=axis)
def _gelu(x):
    return torch.nn.functional.gelu(x, approximate="tanh")
def _silu(x):
    return torch.nn.functional.silu(x)
def _sigmoid(x):
    return torch.sigmoid(x)
def _layernorm(x, axis=-1, eps=1e-5):
    m = x.mean(dim=axis, keepdim=True)
    v = x.var(dim=axis, keepdim=True, unbiased=False)
    return (x - m) / torch.sqrt(v + eps)
def _scatter_add(tgt, idx, src, axis=0):
    return tgt.clone().index_add_(axis, idx, src)
def _segment_sum(src, seg, n):
    out = torch.zeros((n,) + src.shape[1:], dtype=src.dtype)
    return out.index_add_(0, seg, src)
def _pad(x, pw):
    flat = tuple(v for pair in reversed(pw) for v in pair)
    return torch.nn.functional.pad(x, flat)

kernel_name = 'standalone__layernorm_linear__prompt'

def setup_inputs():

    _w = (lambda a: (lambda t: t.to(torch.bfloat16) if t.is_floating_point() else t)(torch.as_tensor(a)))
    B, S, D = 2, 2048, 1024
    return {
        "x": _w((lambda *s: torch.randn(*s, dtype=torch.bfloat16) * 0.05)(B, S, D)),
        "g": _w((lambda *s: torch.randn(*s, dtype=torch.bfloat16) * 0.05)(D) + 1.0),
        "b": _w((lambda *s: torch.randn(*s, dtype=torch.bfloat16) * 0.4)(D)),
        "w": _w((lambda *s: torch.randn(*s, dtype=torch.bfloat16) * 0.05)(D, D)),
    }

def reference(x, g, b, w):
    return (_layernorm(x, axis=-1) * g + b) @ w
```

```asm
; @launch grid=(256,1,1) block=(512,1,1) lds=147968
.amdgcn_target "amdgcn-amd-amdhsa--gfx950"
.text
.globl standalone__layernorm_linear__prompt_kernel
.p2align 8
.type standalone__layernorm_linear__prompt_kernel,@function
standalone__layernorm_linear__prompt_kernel:
  s_cmp_ge_u32 s2, 256
  s_cbranch_scc1 G_done
  s_load_dwordx4 s[4:7], s[0:1], 0
  s_load_dwordx4 s[16:19], s[0:1], 16
  s_load_dwordx4 s[36:39], s[0:1], 32
  s_load_dwordx2 s[44:45], s[0:1], 48
  v_lshrrev_b32 v1, 6, v0
  v_and_b32 v2, 63, v0
  s_and_b32 s23, s2, 7
  s_lshr_b32 s49, s2, 3
  v_readfirstlane_b32 s20, v1
  s_lshl_b32 s21, s23, 2
  s_and_b32 s25, s49, 3
  s_add_u32 s21, s21, s25
  s_lshr_b32 s22, s49, 2
  s_and_b32 s51, s25, 3
  s_lshl_b32 s51, s51, 9
  s_cmp_lt_u32 s20, 4
  s_cbranch_scc1 L_loader
  s_sub_u32 s63, s20, 4
  s_getpc_b64 s[60:61]
L_pc:
  s_sub_u32 s60, s60, L_pc - standalone__layernorm_linear__prompt_kernel
  s_subb_u32 s61, s61, 0
  s_and_b32 s62, s49, 7
  s_lshl_b32 s62, s62, 2
  s_add_u32 s62, s62, s63
  s_mul_i32 s62, s62, ((L_end - standalone__layernorm_linear__prompt_kernel + 127) / 128 + 31) / 32
  v_min_u32 v3, ((L_end - standalone__layernorm_linear__prompt_kernel + 127) / 128 + 31) / 32 - 1, v2
  v_add_u32 v3, s62, v3
  v_min_u32 v3, (L_end - standalone__layernorm_linear__prompt_kernel - 4) / 128, v3
  v_lshlrev_b32 v3, 7, v3
  global_load_dword v255, v3, s[60:61]
  s_branch L_consumer
L_loader:
  v_lshrrev_b32 v5, 4, v2
  s_lshl_b32 s24, s20, 4
  v_add_u32 v3, s24, v5
  v_lshlrev_b32 v3, 11, v3
  v_and_b32 v4, 15, v2
  v_add_u32 v6, 0, v5
  v_lshlrev_b32 v6, 1, v6
  v_xor_b32 v6, v6, v4
  v_lshlrev_b32 v6, 4, v6
  v_add_u32 v12, v6, v3
  v_add_u32 v13, 8192, v12
  v_add_u32 v6, 4, v5
  v_lshlrev_b32 v6, 1, v6
  v_xor_b32 v6, v6, v4
  v_lshlrev_b32 v6, 4, v6
  v_add_u32 v14, v6, v3
  v_add_u32 v14, 16384, v14
  v_add_u32 v15, 8192, v14
  s_lshl_b32 s33, s22, 8
  s_lshl_b32 s34, s20, 12
  v_lshrrev_b32 v3, 3, v2
  v_and_b32 v7, 7, v2
  s_lshl_b32 s24, s20, 5
  v_add_u32 v3, s24, v3
  v_lshlrev_b32 v3, 11, v3
  v_add_u32 v6, 0, v5
  v_xor_b32 v6, v6, v7
  v_lshlrev_b32 v6, 4, v6
  v_add_u32 v8, v6, v3
  v_add_u32 v6, 4, v5
  v_xor_b32 v6, v6, v7
  v_lshlrev_b32 v6, 4, v6
  v_add_u32 v9, v6, v3
  v_add_u32 v9, 16384, v9
  v_add_u32 v10, 32768, v8
  v_add_u32 v11, 32768, v9
  s_lshl_b32 s32, s21, 18
  s_waitcnt lgkmcnt(0)
  s_mov_b32 s8, s4
  s_and_b32 s9, s5, 0xffff
  s_mov_b32 s10, 0x800000
  s_mov_b32 s11, 0x20000
  s_mov_b32 s12, s18
  s_and_b32 s13, s19, 0xffff
  s_mov_b32 s14, 0x200000
  s_mov_b32 s15, 0x20000
  v_lshlrev_b32 v19, 4, v2
  v_add_u32 v87, s51, v19
  v_and_b32 v87, 0x7ff, v87
  s_and_b32 s24, s20, 1
  s_cmp_eq_u32 s24, 0
  s_cselect_b32 s52, s6, s16
  s_cselect_b32 s53, s7, s17
  s_add_u32 s59, s51, 131072
  s_cmp_eq_u32 s24, 0
  s_cselect_b32 s59, s59, 135232
  s_and_b32 s53, s53, 0xffff
  s_mov_b32 s54, 2048
  s_mov_b32 s55, 0x20000
  s_mov_b32 m0, s59
  s_mov_b64 exec, 0xff
  buffer_load_dwordx4 v87, s[52:55], 0 offen lds
  s_mov_b64 exec, -1
  s_add_u32 s56, s51, 0
  s_and_b32 s56, s56, 0x7ff
  s_lshl_b32 s57, s56, 10
  s_add_u32 s56, s56, s32
  s_add_u32 s57, s57, s33
  s_add_u32 m0, s34, 0
  s_nop 0
  buffer_load_dwordx4 v8, s[8:11], s56 offen  lds
  s_add_u32 m0, s34, 16384
  s_nop 0
  buffer_load_dwordx4 v12, s[12:15], s57 offen  lds
  s_add_u32 m0, s34, 1024
  s_nop 0
  buffer_load_dwordx4 v9, s[8:11], s56 offen  lds
  s_add_u32 m0, s34, 17408
  s_nop 0
  buffer_load_dwordx4 v13, s[12:15], s57 offen  lds
  s_add_u32 m0, s34, 2048
  s_nop 0
  buffer_load_dwordx4 v10, s[8:11], s56 offen  lds
  s_add_u32 m0, s34, 18432
  s_nop 0
  buffer_load_dwordx4 v14, s[12:15], s57 offen  lds
  s_add_u32 m0, s34, 3072
  s_nop 0
  buffer_load_dwordx4 v11, s[8:11], s56 offen  lds
  s_add_u32 m0, s34, 19456
  s_nop 0
  buffer_load_dwordx4 v15, s[12:15], s57 offen  lds
  s_and_b32 s24, s20, 1
  s_lshr_b32 s25, s20, 1
  s_lshl_b32 s25, s25, 11
  s_add_u32 s25, s25, 131072
  s_cmp_eq_u32 s24, 0
  s_cselect_b32 s59, s25, 135232
  s_cselect_b64 vcc, -1, 0
  s_cselect_b32 s58, 1024, 0
  s_mov_b32 m0, s59
  v_cndmask_b32 v88, v87, v19, vcc
  buffer_load_dwordx4 v88, s[52:55], 0 offen lds
  s_add_u32 s25, s59, 1024
  s_cmp_eq_u32 s24, 0
  s_cselect_b32 m0, s25, s59
  s_cselect_b32 exec_lo, -1, 0xff
  s_cselect_b32 exec_hi, -1, 0
  buffer_load_dwordx4 v88, s[52:55], s58 offen lds
  s_mov_b64 exec, -1
  s_add_u32 s56, s51, 128
  s_and_b32 s56, s56, 0x7ff
  s_lshl_b32 s57, s56, 10
  s_add_u32 s56, s56, s32
  s_add_u32 s57, s57, s33
  s_add_u32 m0, s34, 32768
  s_nop 0
  buffer_load_dwordx4 v8, s[8:11], s56 offen  lds
  s_add_u32 m0, s34, 49152
  s_nop 0
  buffer_load_dwordx4 v12, s[12:15], s57 offen  lds
  s_add_u32 m0, s34, 33792
  s_nop 0
  buffer_load_dwordx4 v9, s[8:11], s56 offen  lds
  s_add_u32 m0, s34, 50176
  s_nop 0
  buffer_load_dwordx4 v13, s[12:15], s57 offen  lds
  s_add_u32 m0, s34, 34816
  s_nop 0
  buffer_load_dwordx4 v10, s[8:11], s56 offen  lds
  s_add_u32 m0, s34, 51200
  s_nop 0
  buffer_load_dwordx4 v14, s[12:15], s57 offen  lds
  s_add_u32 m0, s34, 35840
  s_nop 0
  buffer_load_dwordx4 v11, s[8:11], s56 offen  lds
  s_add_u32 m0, s34, 52224
  s_nop 0
  buffer_load_dwordx4 v15, s[12:15], s57 offen  lds
  v_mov_b32 v52, 0
  v_mov_b32 v53, 0
  s_mov_b32 s27, 0x3f803f80
  v_lshlrev_b32 v18, 11, v5
  v_lshlrev_b32 v17, 4, v4
  v_add_u32 v16, v18, v17
  s_lshl_b32 s35, s21, 7
  s_lshl_b32 s24, s22, 4
  s_add_u32 s35, s35, s24
  s_lshl_b32 s24, s20, 2
  s_add_u32 s35, s35, s24
  s_mov_b32 s48, s35
  s_lshl_b32 s35, s35, 11
  v_add_u32 v55, s48, v5
  v_lshlrev_b32 v55, 4, v55
  v_add_u32 v55, 1048576, v55
  v_and_b32 v3, 31, v2
  s_lshl_b32 s24, s21, 7
  s_lshl_b32 s25, s20, 5
  s_add_u32 s24, s24, s25
  v_add_u32 v68, s24, v3
  v_lshlrev_b32 v68, 4, v68
  v_add_u32 v68, 1048576, v68
  v_add_u32 v69, s25, v3
  v_lshlrev_b32 v70, 2, v69
  v_lshlrev_b32 v69, 3, v69
  v_add_u32 v69, 137472, v69
  v_lshrrev_b32 v6, 5, v2
  v_lshlrev_b32 v6, 9, v6
  v_add_u32 v70, v70, v6
  v_lshrrev_b32 v6, 5, v2
  v_mul_u32_u24 v6, 16, v6
  v_add_u32 v71, v70, v6
  v_add_u32 v71, 138496, v71
  v_add_u32 v73, 146944, v70
  v_mov_b32 v86, v73
  v_lshlrev_b32 v74, 1, v70
  v_add_u32 v74, 1179648, v74
  s_lshl_b32 s24, s22, 5
  s_add_u32 s25, s24, s21
  s_lshl_b32 s25, s25, 11
  v_add_u32 v75, s25, v74
  s_and_b32 s25, s21, 28
  s_add_u32 s25, s25, s24
  s_lshl_b32 s25, s25, 11
  v_add_u32 v76, s25, v74
  v_add_u32 v77, 4096, v76
  s_waitcnt vmcnt(10)
  s_barrier
  s_add_u32 s56, s51, 256
  s_and_b32 s56, s56, 0x7ff
  s_lshl_b32 s57, s56, 10
  s_add_u32 s56, s56, s32
  s_add_u32 s57, s57, s33
  s_add_u32 m0, s34, 65536
  s_nop 0
  buffer_load_dwordx4 v8, s[8:11], s56 offen  lds
  s_add_u32 m0, s34, 81920
  s_nop 0
  buffer_load_dwordx4 v12, s[12:15], s57 offen  lds
  s_add_u32 m0, s34, 66560
  s_nop 0
  buffer_load_dwordx4 v9, s[8:11], s56 offen  lds
  s_add_u32 m0, s34, 82944
  s_nop 0
  buffer_load_dwordx4 v13, s[12:15], s57 offen  lds
  s_add_u32 m0, s34, 67584
  s_nop 0
  buffer_load_dwordx4 v10, s[8:11], s56 offen  lds
  s_add_u32 m0, s34, 83968
  s_nop 0
  buffer_load_dwordx4 v14, s[12:15], s57 offen  lds
  s_add_u32 m0, s34, 68608
  s_nop 0
  buffer_load_dwordx4 v11, s[8:11], s56 offen  lds
  s_add_u32 m0, s34, 84992
  s_nop 0
  buffer_load_dwordx4 v15, s[12:15], s57 offen  lds
  s_waitcnt vmcnt(8)
  s_barrier
  s_add_u32 s26, s51, 512
  s_and_b32 s26, s26, 0x7ff
  s_add_u32 s26, s26, s35
  buffer_load_dwordx4 v[28:31], v16, s[8:11], s26 offen
  s_add_u32 s26, s51, 768
  s_and_b32 s26, s26, 0x7ff
  s_add_u32 s26, s26, s35
  buffer_load_dwordx4 v[32:35], v16, s[8:11], s26 offen
  s_add_u32 s56, s51, 384
  s_and_b32 s56, s56, 0x7ff
  s_lshl_b32 s57, s56, 10
  s_add_u32 s56, s56, s32
  s_add_u32 s57, s57, s33
  s_add_u32 m0, s34, 98304
  s_nop 0
  buffer_load_dwordx4 v8, s[8:11], s56 offen  lds
  s_add_u32 m0, s34, 114688
  s_nop 0
  buffer_load_dwordx4 v12, s[12:15], s57 offen  lds
  s_add_u32 m0, s34, 99328
  s_nop 0
  buffer_load_dwordx4 v9, s[8:11], s56 offen  lds
  s_add_u32 m0, s34, 115712
  s_nop 0
  buffer_load_dwordx4 v13, s[12:15], s57 offen  lds
  s_add_u32 m0, s34, 100352
  s_nop 0
  buffer_load_dwordx4 v10, s[8:11], s56 offen  lds
  s_add_u32 m0, s34, 116736
  s_nop 0
  buffer_load_dwordx4 v14, s[12:15], s57 offen  lds
  s_add_u32 m0, s34, 101376
  s_nop 0
  buffer_load_dwordx4 v11, s[8:11], s56 offen  lds
  s_add_u32 m0, s34, 117760
  s_nop 0
  buffer_load_dwordx4 v15, s[12:15], s57 offen  lds
  s_waitcnt vmcnt(10)
  s_barrier
  s_add_u32 s56, s51, 512
  s_and_b32 s56, s56, 0x7ff
  s_lshl_b32 s57, s56, 10
  s_add_u32 s56, s56, s32
  s_add_u32 s57, s57, s33
  s_add_u32 m0, s34, 0
  s_nop 0
  buffer_load_dwordx4 v8, s[8:11], s56 offen  lds
  s_add_u32 m0, s34, 16384
  s_nop 0
  buffer_load_dwordx4 v12, s[12:15], s57 offen  lds
  s_add_u32 m0, s34, 1024
  s_nop 0
  buffer_load_dwordx4 v9, s[8:11], s56 offen  lds
  s_add_u32 m0, s34, 17408
  s_nop 0
  buffer_load_dwordx4 v13, s[12:15], s57 offen  lds
  s_add_u32 m0, s34, 2048
  s_nop 0
  buffer_load_dwordx4 v10, s[8:11], s56 offen  lds
  s_add_u32 m0, s34, 18432
  s_nop 0
  buffer_load_dwordx4 v14, s[12:15], s57 offen  lds
  s_add_u32 m0, s34, 3072
  s_nop 0
  buffer_load_dwordx4 v11, s[8:11], s56 offen  lds
  s_add_u32 m0, s34, 19456
  s_nop 0
  buffer_load_dwordx4 v15, s[12:15], s57 offen  lds
  s_waitcnt vmcnt(8)
  s_barrier
  s_add_u32 s26, s51, 1024
  s_and_b32 s26, s26, 0x7ff
  s_add_u32 s26, s26, s35
  buffer_load_dwordx4 v[36:39], v16, s[8:11], s26 offen
  s_add_u32 s26, s51, 1280
  s_and_b32 s26, s26, 0x7ff
  s_add_u32 s26, s26, s35
  buffer_load_dwordx4 v[40:43], v16, s[8:11], s26 offen
  s_add_u32 s26, s51, 0
  s_and_b32 s26, s26, 0x7ff
  s_add_u32 s26, s26, s35
  buffer_load_dwordx4 v[20:23], v16, s[8:11], s26 offen
  s_add_u32 s56, s51, 640
  s_and_b32 s56, s56, 0x7ff
  s_lshl_b32 s57, s56, 10
  s_add_u32 s56, s56, s32
  s_add_u32 s57, s57, s33
  s_add_u32 m0, s34, 32768
  s_nop 0
  buffer_load_dwordx4 v8, s[8:11], s56 offen  lds
  s_add_u32 m0, s34, 49152
  s_nop 0
  buffer_load_dwordx4 v12, s[12:15], s57 offen  lds
  s_add_u32 m0, s34, 33792
  s_nop 0
  buffer_load_dwordx4 v9, s[8:11], s56 offen  lds
  s_add_u32 m0, s34, 50176
  s_nop 0
  buffer_load_dwordx4 v13, s[12:15], s57 offen  lds
  s_add_u32 m0, s34, 34816
  s_nop 0
  buffer_load_dwordx4 v10, s[8:11], s56 offen  lds
  s_add_u32 m0, s34, 51200
  s_nop 0
  buffer_load_dwordx4 v14, s[12:15], s57 offen  lds
  s_add_u32 m0, s34, 35840
  s_nop 0
  buffer_load_dwordx4 v11, s[8:11], s56 offen  lds
  s_add_u32 m0, s34, 52224
  s_nop 0
  buffer_load_dwordx4 v15, s[12:15], s57 offen  lds
  v_dot2c_f32_bf16 v52, s27, v28
  v_dot2c_f32_bf16 v53, v28, v28
  v_dot2c_f32_bf16 v52, s27, v29
  v_dot2c_f32_bf16 v53, v29, v29
  s_waitcnt vmcnt(11)
  s_barrier
  s_add_u32 s56, s51, 768
  s_and_b32 s56, s56, 0x7ff
  s_lshl_b32 s57, s56, 10
  s_add_u32 s56, s56, s32
  s_add_u32 s57, s57, s33
  s_add_u32 m0, s34, 65536
  s_nop 0
  buffer_load_dwordx4 v8, s[8:11], s56 offen  lds
  s_add_u32 m0, s34, 81920
  s_nop 0
  buffer_load_dwordx4 v12, s[12:15], s57 offen  lds
  s_add_u32 m0, s34, 66560
  s_nop 0
  buffer_load_dwordx4 v9, s[8:11], s56 offen  lds
  s_add_u32 m0, s34, 82944
  s_nop 0
  buffer_load_dwordx4 v13, s[12:15], s57 offen  lds
  s_add_u32 m0, s34, 67584
  s_nop 0
  buffer_load_dwordx4 v10, s[8:11], s56 offen  lds
  s_add_u32 m0, s34, 83968
  s_nop 0
  buffer_load_dwordx4 v14, s[12:15], s57 offen  lds
  s_add_u32 m0, s34, 68608
  s_nop 0
  buffer_load_dwordx4 v11, s[8:11], s56 offen  lds
  s_add_u32 m0, s34, 84992
  s_nop 0
  buffer_load_dwordx4 v15, s[12:15], s57 offen  lds
  v_dot2c_f32_bf16 v52, s27, v30
  v_dot2c_f32_bf16 v53, v30, v30
  v_dot2c_f32_bf16 v52, s27, v31
  v_dot2c_f32_bf16 v53, v31, v31
  v_dot2c_f32_bf16 v52, s27, v32
  v_dot2c_f32_bf16 v53, v32, v32
  v_dot2c_f32_bf16 v52, s27, v33
  v_dot2c_f32_bf16 v53, v33, v33
  v_dot2c_f32_bf16 v52, s27, v34
  v_dot2c_f32_bf16 v53, v34, v34
  v_dot2c_f32_bf16 v52, s27, v35
  v_dot2c_f32_bf16 v53, v35, v35
  s_load_dword s28, s[38:39], 0
  s_waitcnt vmcnt(8)
  s_barrier
  s_add_u32 s26, s51, 1536
  s_and_b32 s26, s26, 0x7ff
  s_add_u32 s26, s26, s35
  buffer_load_dwordx4 v[44:47], v16, s[8:11], s26 offen
  s_add_u32 s26, s51, 1792
  s_and_b32 s26, s26, 0x7ff
  s_add_u32 s26, s26, s35
  buffer_load_dwordx4 v[48:51], v16, s[8:11], s26 offen
  s_add_u32 s26, s51, 256
  s_and_b32 s26, s26, 0x7ff
  s_add_u32 s26, s26, s35
  buffer_load_dwordx4 v[24:27], v16, s[8:11], s26 offen
  s_add_u32 s56, s51, 896
  s_and_b32 s56, s56, 0x7ff
  s_lshl_b32 s57, s56, 10
  s_add_u32 s56, s56, s32
  s_add_u32 s57, s57, s33
  s_add_u32 m0, s34, 98304
  s_nop 0
  buffer_load_dwordx4 v8, s[8:11], s56 offen  lds
  s_add_u32 m0, s34, 114688
  s_nop 0
  buffer_load_dwordx4 v12, s[12:15], s57 offen  lds
  s_add_u32 m0, s34, 99328
  s_nop 0
  buffer_load_dwordx4 v9, s[8:11], s56 offen  lds
  s_add_u32 m0, s34, 115712
  s_nop 0
  buffer_load_dwordx4 v13, s[12:15], s57 offen  lds
  s_add_u32 m0, s34, 100352
  s_nop 0
  buffer_load_dwordx4 v10, s[8:11], s56 offen  lds
  s_add_u32 m0, s34, 116736
  s_nop 0
  buffer_load_dwordx4 v14, s[12:15], s57 offen  lds
  s_add_u32 m0, s34, 101376
  s_nop 0
  buffer_load_dwordx4 v11, s[8:11], s56 offen  lds
  s_add_u32 m0, s34, 117760
  s_nop 0
  buffer_load_dwordx4 v15, s[12:15], s57 offen  lds
  v_dot2c_f32_bf16 v52, s27, v20
  v_dot2c_f32_bf16 v53, v20, v20
  v_dot2c_f32_bf16 v52, s27, v21
  v_dot2c_f32_bf16 v53, v21, v21
  s_waitcnt vmcnt(11)
  s_barrier
  s_add_u32 s56, s51, 1024
  s_and_b32 s56, s56, 0x7ff
  s_lshl_b32 s57, s56, 10
  s_add_u32 s56, s56, s32
  s_add_u32 s57, s57, s33
  s_add_u32 m0, s34, 0
  s_nop 0
  buffer_load_dwordx4 v8, s[8:11], s56 offen  lds
  s_add_u32 m0, s34, 16384
  s_nop 0
  buffer_load_dwordx4 v12, s[12:15], s57 offen  lds
  s_add_u32 m0, s34, 1024
  s_nop 0
  buffer_load_dwordx4 v9, s[8:11], s56 offen  lds
  s_add_u32 m0, s34, 17408
  s_nop 0
  buffer_load_dwordx4 v13, s[12:15], s57 offen  lds
  s_add_u32 m0, s34, 2048
  s_nop 0
  buffer_load_dwordx4 v10, s[8:11], s56 offen  lds
  s_add_u32 m0, s34, 18432
  s_nop 0
  buffer_load_dwordx4 v14, s[12:15], s57 offen  lds
  s_add_u32 m0, s34, 3072
  s_nop 0
  buffer_load_dwordx4 v11, s[8:11], s56 offen  lds
  s_add_u32 m0, s34, 19456
  s_nop 0
  buffer_load_dwordx4 v15, s[12:15], s57 offen  lds
  ds_read_b32 v72, v71
  s_waitcnt lgkmcnt(0)
  s_cmp_lg_u32 s28, 0
  s_cbranch_scc1 L_have_nonce
  s_mov_b32 s29, 0
  v_mov_b32 v4, 0
L_nonce_poll:
  global_load_dword v6, v4, s[38:39] sc0 sc1
  s_waitcnt vmcnt(0)
  s_nop 0
  v_readfirstlane_b32 s28, v6
  s_add_u32 s29, s29, 1
  s_cmp_lg_u32 s28, 0
  s_cbranch_scc1 L_have_nonce
  s_cmp_lt_u32 s29, 100000
  s_cbranch_scc1 L_nonce_poll
L_have_nonce:
  v_mov_b32 v73, s28
  global_store_dwordx2 v75, v[72:73], s[44:45] sc0 sc1
  v_dot2c_f32_bf16 v52, s27, v22
  v_dot2c_f32_bf16 v53, v22, v22
  v_dot2c_f32_bf16 v52, s27, v23
  v_dot2c_f32_bf16 v53, v23, v23
  v_dot2c_f32_bf16 v52, s27, v36
  v_dot2c_f32_bf16 v53, v36, v36
  v_dot2c_f32_bf16 v52, s27, v37
  s_waitcnt vmcnt(9)
  s_barrier
  s_add_u32 s56, s51, 1152
  s_and_b32 s56, s56, 0x7ff
  s_lshl_b32 s57, s56, 10
  s_add_u32 s56, s56, s32
  s_add_u32 s57, s57, s33
  s_add_u32 m0, s34, 32768
  s_nop 0
  buffer_load_dwordx4 v8, s[8:11], s56 offen  lds
  s_add_u32 m0, s34, 49152
  s_nop 0
  buffer_load_dwordx4 v12, s[12:15], s57 offen  lds
  s_add_u32 m0, s34, 33792
  s_nop 0
  buffer_load_dwordx4 v9, s[8:11], s56 offen  lds
  s_add_u32 m0, s34, 50176
  s_nop 0
  buffer_load_dwordx4 v13, s[12:15], s57 offen  lds
  s_add_u32 m0, s34, 34816
  s_nop 0
  buffer_load_dwordx4 v10, s[8:11], s56 offen  lds
  s_add_u32 m0, s34, 51200
  s_nop 0
  buffer_load_dwordx4 v14, s[12:15], s57 offen  lds
  s_add_u32 m0, s34, 35840
  s_nop 0
  buffer_load_dwordx4 v11, s[8:11], s56 offen  lds
  s_add_u32 m0, s34, 52224
  s_nop 0
  buffer_load_dwordx4 v15, s[12:15], s57 offen  lds
  v_dot2c_f32_bf16 v53, v37, v37
  v_dot2c_f32_bf16 v52, s27, v38
  v_dot2c_f32_bf16 v53, v38, v38
  v_dot2c_f32_bf16 v52, s27, v39
  v_dot2c_f32_bf16 v53, v39, v39
  v_dot2c_f32_bf16 v52, s27, v40
  v_dot2c_f32_bf16 v53, v40, v40
  v_dot2c_f32_bf16 v52, s27, v41
  v_dot2c_f32_bf16 v53, v41, v41
  v_dot2c_f32_bf16 v52, s27, v42
  v_dot2c_f32_bf16 v53, v42, v42
  v_dot2c_f32_bf16 v52, s27, v43
  v_dot2c_f32_bf16 v53, v43, v43
  s_waitcnt vmcnt(9)
  s_barrier
  s_add_u32 s56, s51, 1280
  s_and_b32 s56, s56, 0x7ff
  s_lshl_b32 s57, s56, 10
  s_add_u32 s56, s56, s32
  s_add_u32 s57, s57, s33
  s_add_u32 m0, s34, 65536
  s_nop 0
  buffer_load_dwordx4 v8, s[8:11], s56 offen  lds
  s_add_u32 m0, s34, 81920
  s_nop 0
  buffer_load_dwordx4 v12, s[12:15], s57 offen  lds
  s_add_u32 m0, s34, 66560
  s_nop 0
  buffer_load_dwordx4 v9, s[8:11], s56 offen  lds
  s_add_u32 m0, s34, 82944
  s_nop 0
  buffer_load_dwordx4 v13, s[12:15], s57 offen  lds
  s_add_u32 m0, s34, 67584
  s_nop 0
  buffer_load_dwordx4 v10, s[8:11], s56 offen  lds
  s_add_u32 m0, s34, 83968
  s_nop 0
  buffer_load_dwordx4 v14, s[12:15], s57 offen  lds
  s_add_u32 m0, s34, 68608
  s_nop 0
  buffer_load_dwordx4 v11, s[8:11], s56 offen  lds
  s_add_u32 m0, s34, 84992
  s_nop 0
  buffer_load_dwordx4 v15, s[12:15], s57 offen  lds
  v_dot2c_f32_bf16 v52, s27, v24
  v_dot2c_f32_bf16 v53, v24, v24
  v_dot2c_f32_bf16 v52, s27, v25
  v_dot2c_f32_bf16 v53, v25, v25
  v_dot2c_f32_bf16 v52, s27, v26
  v_dot2c_f32_bf16 v53, v26, v26
  v_dot2c_f32_bf16 v52, s27, v27
  v_dot2c_f32_bf16 v53, v27, v27
  v_dot2c_f32_bf16 v52, s27, v44
  v_dot2c_f32_bf16 v53, v44, v44
  v_dot2c_f32_bf16 v52, s27, v45
  v_dot2c_f32_bf16 v53, v45, v45
  v_dot2c_f32_bf16 v52, s27, v46
  s_waitcnt vmcnt(8)
  s_barrier
  s_add_u32 s56, s51, 1408
  s_and_b32 s56, s56, 0x7ff
  s_lshl_b32 s57, s56, 10
  s_add_u32 s56, s56, s32
  s_add_u32 s57, s57, s33
  s_add_u32 m0, s34, 98304
  s_nop 0
  buffer_load_dwordx4 v8, s[8:11], s56 offen  lds
  s_add_u32 m0, s34, 114688
  s_nop 0
  buffer_load_dwordx4 v12, s[12:15], s57 offen  lds
  s_add_u32 m0, s34, 99328
  s_nop 0
  buffer_load_dwordx4 v9, s[8:11], s56 offen  lds
  s_add_u32 m0, s34, 115712
  s_nop 0
  buffer_load_dwordx4 v13, s[12:15], s57 offen  lds
  s_add_u32 m0, s34, 100352
  s_nop 0
  buffer_load_dwordx4 v10, s[8:11], s56 offen  lds
  s_add_u32 m0, s34, 116736
  s_nop 0
  buffer_load_dwordx4 v14, s[12:15], s57 offen  lds
  s_add_u32 m0, s34, 101376
  s_nop 0
  buffer_load_dwordx4 v11, s[8:11], s56 offen  lds
  s_add_u32 m0, s34, 117760
  s_nop 0
  buffer_load_dwordx4 v15, s[12:15], s57 offen  lds
  v_dot2c_f32_bf16 v53, v46, v46
  v_dot2c_f32_bf16 v52, s27, v47
  v_dot2c_f32_bf16 v53, v47, v47
  v_dot2c_f32_bf16 v52, s27, v48
  v_dot2c_f32_bf16 v53, v48, v48
  v_dot2c_f32_bf16 v52, s27, v49
  v_dot2c_f32_bf16 v53, v49, v49
  v_dot2c_f32_bf16 v52, s27, v50
  v_dot2c_f32_bf16 v53, v50, v50
  v_dot2c_f32_bf16 v52, s27, v51
  v_dot2c_f32_bf16 v53, v51, v51
  s_waitcnt vmcnt(8)
  s_barrier
  s_add_u32 s56, s51, 1536
  s_and_b32 s56, s56, 0x7ff
  s_lshl_b32 s57, s56, 10
  s_add_u32 s56, s56, s32
  s_add_u32 s57, s57, s33
  s_add_u32 m0, s34, 0
  s_nop 0
  buffer_load_dwordx4 v8, s[8:11], s56 offen  lds
  s_add_u32 m0, s34, 16384
  s_nop 0
  buffer_load_dwordx4 v12, s[12:15], s57 offen  lds
  s_add_u32 m0, s34, 1024
  s_nop 0
  buffer_load_dwordx4 v9, s[8:11], s56 offen  lds
  s_add_u32 m0, s34, 17408
  s_nop 0
  buffer_load_dwordx4 v13, s[12:15], s57 offen  lds
  s_add_u32 m0, s34, 2048
  s_nop 0
  buffer_load_dwordx4 v10, s[8:11], s56 offen  lds
  s_add_u32 m0, s34, 18432
  s_nop 0
  buffer_load_dwordx4 v14, s[12:15], s57 offen  lds
  s_add_u32 m0, s34, 3072
  s_nop 0
  buffer_load_dwordx4 v11, s[8:11], s56 offen  lds
  s_add_u32 m0, s34, 19456
  s_nop 0
  buffer_load_dwordx4 v15, s[12:15], s57 offen  lds
  v_add_f32_dpp v52, v52, v52 quad_perm:[1,0,3,2] row_mask:0xf bank_mask:0xf
  v_add_f32_dpp v53, v53, v53 quad_perm:[1,0,3,2] row_mask:0xf bank_mask:0xf
  s_nop 0
  v_add_f32_dpp v52, v52, v52 quad_perm:[2,3,0,1] row_mask:0xf bank_mask:0xf
  v_add_f32_dpp v53, v53, v53 quad_perm:[2,3,0,1] row_mask:0xf bank_mask:0xf
  s_nop 0
  v_add_f32_dpp v52, v52, v52 row_half_mirror row_mask:0xf bank_mask:0xf
  v_add_f32_dpp v53, v53, v53 row_half_mirror row_mask:0xf bank_mask:0xf
  s_nop 0
  v_add_f32_dpp v52, v52, v52 row_mirror row_mask:0xf bank_mask:0xf
  v_add_f32_dpp v53, v53, v53 row_mirror row_mask:0xf bank_mask:0xf
  s_nop 0
  v_mul_f32 v52, 0x3a800000, v52
  v_mul_f32 v53, 0x3a800000, v53
  v_fma_f32 v53, -v52, v52, v53
  v_max_f32 v53, 0, v53
  v_add_f32 v53, 0x3727c5ac, v53
  s_waitcnt vmcnt(8)
  s_barrier
  s_add_u32 s56, s51, 1664
  s_and_b32 s56, s56, 0x7ff
  s_lshl_b32 s57, s56, 10
  s_add_u32 s56, s56, s32
  s_add_u32 s57, s57, s33
  s_add_u32 m0, s34, 32768
  s_nop 0
  buffer_load_dwordx4 v8, s[8:11], s56 offen  lds
  s_add_u32 m0, s34, 49152
  s_nop 0
  buffer_load_dwordx4 v12, s[12:15], s57 offen  lds
  s_add_u32 m0, s34, 33792
  s_nop 0
  buffer_load_dwordx4 v9, s[8:11], s56 offen  lds
  s_add_u32 m0, s34, 50176
  s_nop 0
  buffer_load_dwordx4 v13, s[12:15], s57 offen  lds
  s_add_u32 m0, s34, 34816
  s_nop 0
  buffer_load_dwordx4 v10, s[8:11], s56 offen  lds
  s_add_u32 m0, s34, 51200
  s_nop 0
  buffer_load_dwordx4 v14, s[12:15], s57 offen  lds
  s_add_u32 m0, s34, 35840
  s_nop 0
  buffer_load_dwordx4 v11, s[8:11], s56 offen  lds
  s_add_u32 m0, s34, 52224
  s_nop 0
  buffer_load_dwordx4 v15, s[12:15], s57 offen  lds
  v_rsq_f32 v56, v53
  s_nop 0
  v_mul_f32 v58, v52, v56
  v_sub_f32 v58, 0, v58
  s_waitcnt lgkmcnt(0)
  s_mov_b32 s30, 0x00010001
  s_mov_b32 s31, 0x00010001
  s_mov_b64 exec, s[30:31]
  v_mov_b32 v57, s28
  v_mov_b32 v59, s28
  global_store_dwordx4 v55, v[56:59], s[44:45] sc0 sc1
  s_mov_b64 exec, -1
  s_waitcnt vmcnt(9)
  s_barrier
  s_add_u32 s56, s51, 1792
  s_and_b32 s56, s56, 0x7ff
  s_lshl_b32 s57, s56, 10
  s_add_u32 s56, s56, s32
  s_add_u32 s57, s57, s33
  s_add_u32 m0, s34, 65536
  s_nop 0
  buffer_load_dwordx4 v8, s[8:11], s56 offen  lds
  s_add_u32 m0, s34, 81920
  s_nop 0
  buffer_load_dwordx4 v12, s[12:15], s57 offen  lds
  s_add_u32 m0, s34, 66560
  s_nop 0
  buffer_load_dwordx4 v9, s[8:11], s56 offen  lds
  s_add_u32 m0, s34, 82944
  s_nop 0
  buffer_load_dwordx4 v13, s[12:15], s57 offen  lds
  s_add_u32 m0, s34, 67584
  s_nop 0
  buffer_load_dwordx4 v10, s[8:11], s56 offen  lds
  s_add_u32 m0, s34, 83968
  s_nop 0
  buffer_load_dwordx4 v14, s[12:15], s57 offen  lds
  s_add_u32 m0, s34, 68608
  s_nop 0
  buffer_load_dwordx4 v11, s[8:11], s56 offen  lds
  s_add_u32 m0, s34, 84992
  s_nop 0
  buffer_load_dwordx4 v15, s[12:15], s57 offen  lds
  s_waitcnt vmcnt(9)
  s_barrier
  s_add_u32 s56, s51, 1920
  s_and_b32 s56, s56, 0x7ff
  s_lshl_b32 s57, s56, 10
  s_add_u32 s56, s56, s32
  s_add_u32 s57, s57, s33
  s_add_u32 m0, s34, 98304
  s_nop 0
  buffer_load_dwordx4 v8, s[8:11], s56 offen  lds
  s_add_u32 m0, s34, 114688
  s_nop 0
  buffer_load_dwordx4 v12, s[12:15], s57 offen  lds
  s_add_u32 m0, s34, 99328
  s_nop 0
  buffer_load_dwordx4 v9, s[8:11], s56 offen  lds
  s_add_u32 m0, s34, 115712
  s_nop 0
  buffer_load_dwordx4 v13, s[12:15], s57 offen  lds
  s_add_u32 m0, s34, 100352
  s_nop 0
  buffer_load_dwordx4 v10, s[8:11], s56 offen  lds
  s_add_u32 m0, s34, 116736
  s_nop 0
  buffer_load_dwordx4 v14, s[12:15], s57 offen  lds
  s_add_u32 m0, s34, 101376
  s_nop 0
  buffer_load_dwordx4 v11, s[8:11], s56 offen  lds
  s_add_u32 m0, s34, 117760
  s_nop 0
  buffer_load_dwordx4 v15, s[12:15], s57 offen  lds
  s_waitcnt vmcnt(8)
  s_barrier
  global_load_dwordx2 v[78:79], v76, s[44:45] offset:0 sc0 sc1
  global_load_dwordx2 v[80:81], v76, s[44:45] offset:2048 sc0 sc1
  global_load_dwordx2 v[82:83], v77, s[44:45] offset:0 sc0 sc1
  global_load_dwordx2 v[84:85], v77, s[44:45] offset:2048 sc0 sc1
  global_load_dwordx4 v[64:67], v68, s[44:45] sc0 sc1
  s_waitcnt vmcnt(5)
  s_barrier
  s_mov_b32 s29, 0
L_stat_check:
  s_waitcnt vmcnt(0)
  v_cmp_eq_u32 s[30:31], s28, v65
  v_cmp_eq_u32 vcc, s28, v67
  s_add_u32 s29, s29, 1
  s_nop 1
  s_and_b64 s[30:31], vcc, s[30:31]
  v_cmp_eq_u32 vcc, s28, v79
  s_nop 3
  s_and_b64 s[30:31], vcc, s[30:31]
  v_cmp_eq_u32 vcc, s28, v81
  s_nop 3
  s_and_b64 s[30:31], vcc, s[30:31]
  v_cmp_eq_u32 vcc, s28, v83
  s_nop 3
  s_and_b64 s[30:31], vcc, s[30:31]
  v_cmp_eq_u32 vcc, s28, v85
  s_nop 3
  s_and_b64 s[30:31], vcc, s[30:31]
  s_cmp_eq_u64 s[30:31], exec
  s_cbranch_scc1 L_stat_ok
  s_cmp_ge_u32 s29, 100000
  s_cbranch_scc1 L_stat_ok
  s_sleep 2
  global_load_dwordx4 v[64:67], v68, s[44:45] sc0 sc1
  global_load_dwordx2 v[78:79], v76, s[44:45] offset:0 sc0 sc1
  global_load_dwordx2 v[80:81], v76, s[44:45] offset:2048 sc0 sc1
  global_load_dwordx2 v[82:83], v77, s[44:45] offset:0 sc0 sc1
  global_load_dwordx2 v[84:85], v77, s[44:45] offset:2048 sc0 sc1
  s_branch L_stat_check
L_stat_ok:
  v_mov_b32 v65, v66
  v_add_f32 v78, v78, v80
  v_add_f32 v82, v82, v84
  ds_write_b64 v69, v[64:65]
  v_add_f32 v78, v78, v82
  ds_write_b32 v86, v78
  s_waitcnt lgkmcnt(0)
  s_barrier
  s_endpgm
L_consumer:
  s_sub_u32 s20, s20, 4
  s_setprio 1
  v_mov_b32 v204, v2
  s_lshl_b32 s24, s20, 6
  v_add_u32 v194, s24, v204
  v_lshlrev_b32 v196, 3, v194
  s_waitcnt lgkmcnt(0)
  s_or_b32 s24, s2, s20
  s_cmp_lg_u32 s24, 0
  s_cbranch_scc1 L_no_nonce
  s_memrealtime s[28:29]
  s_waitcnt lgkmcnt(0)
  s_or_b32 s28, s28, 1
  v_mov_b32 v197, s28
  v_mov_b32 v198, 0
  s_mov_b64 exec, 1
  global_store_dword v198, v197, s[38:39] sc0 sc1
  s_mov_b64 exec, -1
L_no_nonce:
  v_and_b32 v197, 3, v204
  v_mov_b32 v250, 0
  v_mov_b32 v251, 0
  v_mov_b32 v200, 0xffff
  v_mov_b32 v201, 0xffff0000
  v_cmp_eq_u32 vcc, 0, v197
  s_nop 1
  v_cndmask_b32 v250, v250, v200, vcc
  v_cmp_eq_u32 vcc, 1, v197
  s_nop 1
  v_cndmask_b32 v250, v250, v201, vcc
  v_cmp_eq_u32 vcc, 2, v197
  s_nop 1
  v_cndmask_b32 v251, v251, v200, vcc
  v_cmp_eq_u32 vcc, 3, v197
  s_nop 1
  v_cndmask_b32 v251, v251, v201, vcc
  v_and_b32 v197, 15, v204
  v_lshrrev_b32 v200, 4, v204
  v_lshrrev_b32 v201, 1, v197
  v_lshlrev_b32 v202, 7, v197
  v_add_u32 v203, 0, v200
  v_xor_b32 v203, v203, v201
  v_lshlrev_b32 v203, 4, v203
  v_add_u32 v184, v202, v203
  v_add_u32 v186, 0x10000, v184
  v_add_u32 v203, 4, v200
  v_xor_b32 v203, v203, v201
  v_lshlrev_b32 v203, 4, v203
  v_add_u32 v185, v202, v203
  v_add_u32 v187, 0x10000, v185
  v_lshrrev_b32 v201, 2, v197
  v_and_b32 v202, 1, v200
  v_lshlrev_b32 v202, 2, v202
  v_or_b32 v202, v202, v201
  v_lshlrev_b32 v203, 3, v200
  v_add_u32 v203, v203, v201
  v_lshlrev_b32 v203, 8, v203
  v_and_b32 v201, 3, v204
  v_lshlrev_b32 v201, 3, v201
  v_add_u32 v203, v203, v201
  v_add_u32 v203, 16384, v203
  s_lshl_b32 s24, s20, 1
  s_add_u32 s25, s24, 0
  v_xor_b32 v201, s25, v202
  v_lshlrev_b32 v201, 5, v201
  v_add_u32 v188, v203, v201
  v_add_u32 v190, 0x10000, v188
  s_add_u32 s25, s24, 1
  v_xor_b32 v201, s25, v202
  v_lshlrev_b32 v201, 5, v201
  v_add_u32 v189, v203, v201
  v_add_u32 v191, 0x10000, v189
  v_lshlrev_b32 v201, 4, v200
  v_add_u32 v192, 131072, v201
  v_add_u32 v192, s51, v192
  v_lshlrev_b32 v202, 4, v200
  v_mov_b32 v193, 136320
  v_mov_b32 v201, 135232
  v_cmp_eq_u32 vcc, 1, v197
  s_nop 1
  v_cndmask_b32 v193, v193, v201, vcc
  v_add_u32 v193, v193, v202
  v_mov_b32 v244, 0
  v_mov_b32 v201, 0x3f803f80
  v_cmp_eq_u32 vcc, 0, v197
  s_nop 1
  v_cndmask_b32 v244, v244, v201, vcc
  v_mov_b32 v245, v244
  v_mov_b32 v246, v244
  v_mov_b32 v247, v244
  v_lshlrev_b32 v201, 4, v200
  s_lshl_b32 s24, s20, 7
  v_add_u32 v201, s24, v201
  v_add_u32 v253, 146944, v201
  v_mul_u32_u24 v202, 528, v197
  v_add_u32 v201, v201, v202
  v_add_u32 v252, 138496, v201
  v_mov_b32 v0, 0
  v_mov_b32 v1, 0
  v_lshlrev_b32 v248, 3, v197
  v_add_u32 v248, 137472, v248
  s_lshl_b32 s24, s21, 7
  v_add_u32 v249, s24, v197
  v_lshlrev_b32 v249, 11, v249
  v_and_b32 v201, 1, v200
  v_lshlrev_b32 v201, 5, v201
  v_lshrrev_b32 v202, 1, v200
  v_lshlrev_b32 v202, 4, v202
  v_add_u32 v201, v201, v202
  s_lshl_b32 s24, s22, 8
  s_lshl_b32 s25, s20, 6
  s_add_u32 s24, s24, s25
  v_add_u32 v249, v249, v201
  v_add_u32 v249, s24, v249
  s_mov_b32 s28, s36
  s_and_b32 s29, s37, 0xffff
  s_mov_b32 s30, 0x800000
  s_mov_b32 s31, 0x20000
  v_lshlrev_b32 v202, 3, v204
  v_add_u32 v202, 136320, v202
  ds_write_b64 v202, v[0:1]
  ds_write_b64 v202, v[0:1] offset:512
  s_waitcnt lgkmcnt(0)
  s_barrier
  ds_read_b128 v[144:147], v192 offset:0
  ds_read_b64_tr_b16 v[136:137], v188 offset:0
  ds_read_b64_tr_b16 v[138:139], v188 offset:1024
  ds_read_b64_tr_b16 v[140:141], v189 offset:0
  ds_read_b64_tr_b16 v[142:143], v189 offset:1024
  ds_read_b128 v[148:151], v193 offset:0
  ds_read_b128 v[72:75], v184 offset:0
  ds_read_b128 v[76:79], v184 offset:2048
  ds_read_b128 v[80:83], v184 offset:4096
  ds_read_b128 v[84:87], v184 offset:6144
  ds_read_b128 v[88:91], v184 offset:8192
  ds_read_b128 v[92:95], v184 offset:10240
  ds_read_b128 v[96:99], v184 offset:12288
  ds_read_b128 v[100:103], v184 offset:14336
  s_waitcnt lgkmcnt(8)
  v_and_b32 v144, v144, v250
  v_and_b32 v145, v145, v251
  v_and_b32 v146, v146, v250
  v_and_b32 v147, v147, v251
  s_nop 1
  v_mfma_f32_4x4x4_16b_bf16 v[152:155], v[144:145], v[136:137], 0
  v_mfma_f32_4x4x4_16b_bf16 v[156:159], v[146:147], v[138:139], 0
  v_mfma_f32_4x4x4_16b_bf16 v[160:163], v[144:145], v[140:141], 0
  v_mfma_f32_4x4x4_16b_bf16 v[164:167], v[146:147], v[142:143], 0
  v_mfma_f32_16x16x32_bf16 v[64:67], v[136:139], v[148:151], 0
  v_mfma_f32_16x16x32_bf16 v[68:71], v[140:143], v[148:151], 0
  s_nop 4
  v_cvt_pk_bf16_f32 v168, v152, v153
  v_cvt_pk_bf16_f32 v169, v154, v155
  v_cvt_pk_bf16_f32 v170, v156, v157
  v_cvt_pk_bf16_f32 v171, v158, v159
  v_cvt_pk_bf16_f32 v172, v160, v161
  v_cvt_pk_bf16_f32 v173, v162, v163
  v_cvt_pk_bf16_f32 v174, v164, v165
  v_cvt_pk_bf16_f32 v175, v166, v167
  ds_read_b128 v[144:147], v192 offset:64
  ds_read_b64_tr_b16 v[136:137], v188 offset:8192
  ds_read_b64_tr_b16 v[138:139], v188 offset:9216
  ds_read_b64_tr_b16 v[140:141], v189 offset:8192
  ds_read_b64_tr_b16 v[142:143], v189 offset:9216
  ds_read_b128 v[148:151], v193 offset:64
  s_waitcnt lgkmcnt(5)
  v_mfma_f32_16x16x32_bf16 v[0:3], v[168:171], v[72:75], 0
  ds_read_b128 v[104:107], v185 offset:0
  v_and_b32 v144, v144, v250
  v_mfma_f32_16x16x32_bf16 v[8:11], v[168:171], v[76:79], 0
  ds_read_b128 v[108:111], v185 offset:2048
  v_and_b32 v145, v145, v251
  v_mfma_f32_16x16x32_bf16 v[64:67], v[168:171], v[244:247], v[64:67]
  v_mfma_f32_16x16x32_bf16 v[68:71], v[172:175], v[244:247], v[68:71]
  v_mfma_f32_16x16x32_bf16 v[16:19], v[168:171], v[80:83], 0
  ds_read_b128 v[112:115], v185 offset:4096
  v_and_b32 v146, v146, v250
  v_mfma_f32_16x16x32_bf16 v[24:27], v[168:171], v[84:87], 0
  ds_read_b128 v[116:119], v185 offset:6144
  v_and_b32 v147, v147, v251
  v_mfma_f32_16x16x32_bf16 v[32:35], v[168:171], v[88:91], 0
  ds_read_b128 v[120:123], v185 offset:8192
  s_waitcnt lgkmcnt(5)
  v_mfma_f32_4x4x4_16b_bf16 v[152:155], v[144:145], v[136:137], 0
  v_mfma_f32_4x4x4_16b_bf16 v[156:159], v[146:147], v[138:139], 0
  v_mfma_f32_4x4x4_16b_bf16 v[160:163], v[144:145], v[140:141], 0
  v_mfma_f32_4x4x4_16b_bf16 v[164:167], v[146:147], v[142:143], 0
  v_mfma_f32_16x16x32_bf16 v[40:43], v[168:171], v[92:95], 0
  ds_read_b128 v[124:127], v185 offset:10240
  v_mfma_f32_16x16x32_bf16 v[64:67], v[136:139], v[148:151], v[64:67]
  v_mfma_f32_16x16x32_bf16 v[68:71], v[140:143], v[148:151], v[68:71]
  v_mfma_f32_16x16x32_bf16 v[48:51], v[168:171], v[96:99], 0
  ds_read_b128 v[128:131], v185 offset:12288
  v_cvt_pk_bf16_f32 v176, v152, v153
  v_mfma_f32_16x16x32_bf16 v[56:59], v[168:171], v[100:103], 0
  ds_read_b128 v[132:135], v185 offset:14336
  v_cvt_pk_bf16_f32 v177, v154, v155
  s_barrier
  v_mfma_f32_16x16x32_bf16 v[60:63], v[172:175], v[100:103], 0
  ds_read_b128 v[144:147], v192 offset:128
  v_cvt_pk_bf16_f32 v178, v156, v157
  v_mfma_f32_16x16x32_bf16 v[52:55], v[172:175], v[96:99], 0
  ds_read_b64_tr_b16 v[136:137], v188 offset:32768
  v_cvt_pk_bf16_f32 v179, v158, v159
  v_mfma_f32_16x16x32_bf16 v[44:47], v[172:175], v[92:95], 0
  ds_read_b64_tr_b16 v[138:139], v188 offset:33792
  v_cvt_pk_bf16_f32 v180, v160, v161
  v_mfma_f32_16x16x32_bf16 v[36:39], v[172:175], v[88:91], 0
  ds_read_b64_tr_b16 v[140:141], v189 offset:32768
  v_cvt_pk_bf16_f32 v181, v162, v163
  v_mfma_f32_16x16x32_bf16 v[28:31], v[172:175], v[84:87], 0
  ds_read_b64_tr_b16 v[142:143], v189 offset:33792
  v_cvt_pk_bf16_f32 v182, v164, v165
  v_mfma_f32_16x16x32_bf16 v[20:23], v[172:175], v[80:83], 0
  ds_read_b128 v[148:151], v193 offset:128
  v_cvt_pk_bf16_f32 v183, v166, v167
  v_mfma_f32_16x16x32_bf16 v[12:15], v[172:175], v[76:79], 0
  v_mfma_f32_16x16x32_bf16 v[4:7], v[172:175], v[72:75], 0
  s_waitcnt lgkmcnt(5)
  v_mfma_f32_16x16x32_bf16 v[0:3], v[176:179], v[104:107], v[0:3]
  ds_read_b128 v[72:75], v184 offset:32768
  v_and_b32 v144, v144, v250
  v_mfma_f32_16x16x32_bf16 v[8:11], v[176:179], v[108:111], v[8:11]
  ds_read_b128 v[76:79], v184 offset:34816
  v_and_b32 v145, v145, v251
  v_mfma_f32_16x16x32_bf16 v[64:67], v[176:179], v[244:247], v[64:67]
  v_mfma_f32_16x16x32_bf16 v[68:71], v[180:183], v[244:247], v[68:71]
  v_mfma_f32_16x16x32_bf16 v[16:19], v[176:179], v[112:115], v[16:19]
  ds_read_b128 v[80:83], v184 offset:36864
  v_and_b32 v146, v146, v250
  v_mfma_f32_16x16x32_bf16 v[24:27], v[176:179], v[116:119], v[24:27]
  ds_read_b128 v[84:87], v184 offset:38912
  v_and_b32 v147, v147, v251
  v_mfma_f32_16x16x32_bf16 v[32:35], v[176:179], v[120:123], v[32:35]
  ds_read_b128 v[88:91], v184 offset:40960
  s_waitcnt lgkmcnt(5)
  v_mfma_f32_4x4x4_16b_bf16 v[152:155], v[144:145], v[136:137], 0
  v_mfma_f32_4x4x4_16b_bf16 v[156:159], v[146:147], v[138:139], 0
  v_mfma_f32_4x4x4_16b_bf16 v[160:163], v[144:145], v[140:141], 0
  v_mfma_f32_4x4x4_16b_bf16 v[164:167], v[146:147], v[142:143], 0
  v_mfma_f32_16x16x32_bf16 v[40:43], v[176:179], v[124:127], v[40:43]
  ds_read_b128 v[92:95], v184 offset:43008
  v_mfma_f32_16x16x32_bf16 v[64:67], v[136:139], v[148:151], v[64:67]
  v_mfma_f32_16x16x32_bf16 v[68:71], v[140:143], v[148:151], v[68:71]
  v_mfma_f32_16x16x32_bf16 v[48:51], v[176:179], v[128:131], v[48:51]
  ds_read_b128 v[96:99], v184 offset:45056
  v_cvt_pk_bf16_f32 v168, v152, v153
  v_mfma_f32_16x16x32_bf16 v[56:59], v[176:179], v[132:135], v[56:59]
  ds_read_b128 v[100:103], v184 offset:47104
  v_cvt_pk_bf16_f32 v169, v154, v155
  v_mfma_f32_16x16x32_bf16 v[60:63], v[180:183], v[132:135], v[60:63]
  ds_read_b128 v[144:147], v192 offset:192
  v_cvt_pk_bf16_f32 v170, v156, v157
  v_mfma_f32_16x16x32_bf16 v[52:55], v[180:183], v[128:131], v[52:55]
  ds_read_b64_tr_b16 v[136:137], v188 offset:40960
  v_cvt_pk_bf16_f32 v171, v158, v159
  v_mfma_f32_16x16x32_bf16 v[44:47], v[180:183], v[124:127], v[44:47]
  ds_read_b64_tr_b16 v[138:139], v188 offset:41984
  v_cvt_pk_bf16_f32 v172, v160, v161
  v_mfma_f32_16x16x32_bf16 v[36:39], v[180:183], v[120:123], v[36:39]
  ds_read_b64_tr_b16 v[140:141], v189 offset:40960
  v_cvt_pk_bf16_f32 v173, v162, v163
  v_mfma_f32_16x16x32_bf16 v[28:31], v[180:183], v[116:119], v[28:31]
  ds_read_b64_tr_b16 v[142:143], v189 offset:41984
  v_cvt_pk_bf16_f32 v174, v164, v165
  v_mfma_f32_16x16x32_bf16 v[20:23], v[180:183], v[112:115], v[20:23]
  ds_read_b128 v[148:151], v193 offset:192
  v_cvt_pk_bf16_f32 v175, v166, v167
  v_mfma_f32_16x16x32_bf16 v[12:15], v[180:183], v[108:111], v[12:15]
  v_mfma_f32_16x16x32_bf16 v[4:7], v[180:183], v[104:107], v[4:7]
  s_waitcnt lgkmcnt(5)
  v_mfma_f32_16x16x32_bf16 v[0:3], v[168:171], v[72:75], v[0:3]
  ds_read_b128 v[104:107], v185 offset:32768
  v_and_b32 v144, v144, v250
  v_mfma_f32_16x16x32_bf16 v[8:11], v[168:171], v[76:79], v[8:11]
  ds_read_b128 v[108:111], v185 offset:34816
  v_and_b32 v145, v145, v251
  v_mfma_f32_16x16x32_bf16 v[64:67], v[168:171], v[244:247], v[64:67]
  v_mfma_f32_16x16x32_bf16 v[68:71], v[172:175], v[244:247], v[68:71]
  v_mfma_f32_16x16x32_bf16 v[16:19], v[168:171], v[80:83], v[16:19]
  ds_read_b128 v[112:115], v185 offset:36864
  v_and_b32 v146, v146, v250
  v_mfma_f32_16x16x32_bf16 v[24:27], v[168:171], v[84:87], v[24:27]
  ds_read_b128 v[116:119], v185 offset:38912
  v_and_b32 v147, v147, v251
  v_mfma_f32_16x16x32_bf16 v[32:35], v[168:171], v[88:91], v[32:35]
  ds_read_b128 v[120:123], v185 offset:40960
  s_waitcnt lgkmcnt(5)
  v_mfma_f32_4x4x4_16b_bf16 v[152:155], v[144:145], v[136:137], 0
  v_mfma_f32_4x4x4_16b_bf16 v[156:159], v[146:147], v[138:139], 0
  v_mfma_f32_4x4x4_16b_bf16 v[160:163], v[144:145], v[140:141], 0
  v_mfma_f32_4x4x4_16b_bf16 v[164:167], v[146:147], v[142:143], 0
  v_mfma_f32_16x16x32_bf16 v[40:43], v[168:171], v[92:95], v[40:43]
  ds_read_b128 v[124:127], v185 offset:43008
  v_mfma_f32_16x16x32_bf16 v[64:67], v[136:139], v[148:151], v[64:67]
  v_mfma_f32_16x16x32_bf16 v[68:71], v[140:143], v[148:151], v[68:71]
  v_mfma_f32_16x16x32_bf16 v[48:51], v[168:171], v[96:99], v[48:51]
  ds_read_b128 v[128:131], v185 offset:45056
  v_cvt_pk_bf16_f32 v176, v152, v153
  v_mfma_f32_16x16x32_bf16 v[56:59], v[168:171], v[100:103], v[56:59]
  ds_read_b128 v[132:135], v185 offset:47104
  v_cvt_pk_bf16_f32 v177, v154, v155
  s_barrier
  v_mfma_f32_16x16x32_bf16 v[60:63], v[172:175], v[100:103], v[60:63]
  ds_read_b128 v[144:147], v192 offset:256
  v_cvt_pk_bf16_f32 v178, v156, v157
  v_mfma_f32_16x16x32_bf16 v[52:55], v[172:175], v[96:99], v[52:55]
  ds_read_b64_tr_b16 v[136:137], v190 offset:0
  v_cvt_pk_bf16_f32 v179, v158, v159
  v_mfma_f32_16x16x32_bf16 v[44:47], v[172:175], v[92:95], v[44:47]
  ds_read_b64_tr_b16 v[138:139], v190 offset:1024
  v_cvt_pk_bf16_f32 v180, v160, v161
  v_mfma_f32_16x16x32_bf16 v[36:39], v[172:175], v[88:91], v[36:39]
  ds_read_b64_tr_b16 v[140:141], v191 offset:0
  v_cvt_pk_bf16_f32 v181, v162, v163
  v_mfma_f32_16x16x32_bf16 v[28:31], v[172:175], v[84:87], v[28:31]
  ds_read_b64_tr_b16 v[142:143], v191 offset:1024
  v_cvt_pk_bf16_f32 v182, v164, v165
  v_mfma_f32_16x16x32_bf16 v[20:23], v[172:175], v[80:83], v[20:23]
  ds_read_b128 v[148:151], v193 offset:256
  v_cvt_pk_bf16_f32 v183, v166, v167
  v_mfma_f32_16x16x32_bf16 v[12:15], v[172:175], v[76:79], v[12:15]
  v_mfma_f32_16x16x32_bf16 v[4:7], v[172:175], v[72:75], v[4:7]
  s_waitcnt lgkmcnt(5)
  v_mfma_f32_16x16x32_bf16 v[0:3], v[176:179], v[104:107], v[0:3]
  ds_read_b128 v[72:75], v186 offset:0
  v_and_b32 v144, v144, v250
  v_mfma_f32_16x16x32_bf16 v[8:11], v[176:179], v[108:111], v[8:11]
  ds_read_b128 v[76:79], v186 offset:2048
  v_and_b32 v145, v145, v251
  v_mfma_f32_16x16x32_bf16 v[64:67], v[176:179], v[244:247], v[64:67]
  v_mfma_f32_16x16x32_bf16 v[68:71], v[180:183], v[244:247], v[68:71]
  v_mfma_f32_16x16x32_bf16 v[16:19], v[176:179], v[112:115], v[16:19]
  ds_read_b128 v[80:83], v186 offset:4096
  v_and_b32 v146, v146, v250
  v_mfma_f32_16x16x32_bf16 v[24:27], v[176:179], v[116:119], v[24:27]
  ds_read_b128 v[84:87], v186 offset:6144
  v_and_b32 v147, v147, v251
  v_mfma_f32_16x16x32_bf16 v[32:35], v[176:179], v[120:123], v[32:35]
  ds_read_b128 v[88:91], v186 offset:8192
  s_waitcnt lgkmcnt(5)
  v_mfma_f32_4x4x4_16b_bf16 v[152:155], v[144:145], v[136:137], 0
  v_mfma_f32_4x4x4_16b_bf16 v[156:159], v[146:147], v[138:139], 0
  v_mfma_f32_4x4x4_16b_bf16 v[160:163], v[144:145], v[140:141], 0
  v_mfma_f32_4x4x4_16b_bf16 v[164:167], v[146:147], v[142:143], 0
  v_mfma_f32_16x16x32_bf16 v[40:43], v[176:179], v[124:127], v[40:43]
  ds_read_b128 v[92:95], v186 offset:10240
  v_mfma_f32_16x16x32_bf16 v[64:67], v[136:139], v[148:151], v[64:67]
  v_mfma_f32_16x16x32_bf16 v[68:71], v[140:143], v[148:151], v[68:71]
  v_mfma_f32_16x16x32_bf16 v[48:51], v[176:179], v[128:131], v[48:51]
  ds_read_b128 v[96:99], v186 offset:12288
  v_cvt_pk_bf16_f32 v168, v152, v153
  v_mfma_f32_16x16x32_bf16 v[56:59], v[176:179], v[132:135], v[56:59]
  ds_read_b128 v[100:103], v186 offset:14336
  v_cvt_pk_bf16_f32 v169, v154, v155
  v_mfma_f32_16x16x32_bf16 v[60:63], v[180:183], v[132:135], v[60:63]
  ds_read_b128 v[144:147], v192 offset:320
  v_cvt_pk_bf16_f32 v170, v156, v157
  v_mfma_f32_16x16x32_bf16 v[52:55], v[180:183], v[128:131], v[52:55]
  ds_read_b64_tr_b16 v[136:137], v190 offset:8192
  v_cvt_pk_bf16_f32 v171, v158, v159
  v_mfma_f32_16x16x32_bf16 v[44:47], v[180:183], v[124:127], v[44:47]
  ds_read_b64_tr_b16 v[138:139], v190 offset:9216
  v_cvt_pk_bf16_f32 v172, v160, v161
  v_mfma_f32_16x16x32_bf16 v[36:39], v[180:183], v[120:123], v[36:39]
  ds_read_b64_tr_b16 v[140:141], v191 offset:8192
  v_cvt_pk_bf16_f32 v173, v162, v163
  v_mfma_f32_16x16x32_bf16 v[28:31], v[180:183], v[116:119], v[28:31]
  ds_read_b64_tr_b16 v[142:143], v191 offset:9216
  v_cvt_pk_bf16_f32 v174, v164, v165
  v_mfma_f32_16x16x32_bf16 v[20:23], v[180:183], v[112:115], v[20:23]
  ds_read_b128 v[148:151], v193 offset:320
  v_cvt_pk_bf16_f32 v175, v166, v167
  v_mfma_f32_16x16x32_bf16 v[12:15], v[180:183], v[108:111], v[12:15]
  v_mfma_f32_16x16x32_bf16 v[4:7], v[180:183], v[104:107], v[4:7]
  s_waitcnt lgkmcnt(5)
  v_mfma_f32_16x16x32_bf16 v[0:3], v[168:171], v[72:75], v[0:3]
  ds_read_b128 v[104:107], v187 offset:0
  v_and_b32 v144, v144, v250
  v_mfma_f32_16x16x32_bf16 v[8:11], v[168:171], v[76:79], v[8:11]
  ds_read_b128 v[108:111], v187 offset:2048
  v_and_b32 v145, v145, v251
  v_mfma_f32_16x16x32_bf16 v[64:67], v[168:171], v[244:247], v[64:67]
  v_mfma_f32_16x16x32_bf16 v[68:71], v[172:175], v[244:247], v[68:71]
  v_mfma_f32_16x16x32_bf16 v[16:19], v[168:171], v[80:83], v[16:19]
  ds_read_b128 v[112:115], v187 offset:4096
  v_and_b32 v146, v146, v250
  v_mfma_f32_16x16x32_bf16 v[24:27], v[168:171], v[84:87], v[24:27]
  ds_read_b128 v[116:119], v187 offset:6144
  v_and_b32 v147, v147, v251
  v_mfma_f32_16x16x32_bf16 v[32:35], v[168:171], v[88:91], v[32:35]
  ds_read_b128 v[120:123], v187 offset:8192
  s_waitcnt lgkmcnt(5)
  v_mfma_f32_4x4x4_16b_bf16 v[152:155], v[144:145], v[136:137], 0
  v_mfma_f32_4x4x4_16b_bf16 v[156:159], v[146:147], v[138:139], 0
  v_mfma_f32_4x4x4_16b_bf16 v[160:163], v[144:145], v[140:141], 0
  v_mfma_f32_4x4x4_16b_bf16 v[164:167], v[146:147], v[142:143], 0
  v_mfma_f32_16x16x32_bf16 v[40:43], v[168:171], v[92:95], v[40:43]
  ds_read_b128 v[124:127], v187 offset:10240
  v_mfma_f32_16x16x32_bf16 v[64:67], v[136:139], v[148:151], v[64:67]
  v_mfma_f32_16x16x32_bf16 v[68:71], v[140:143], v[148:151], v[68:71]
  v_mfma_f32_16x16x32_bf16 v[48:51], v[168:171], v[96:99], v[48:51]
  ds_read_b128 v[128:131], v187 offset:12288
  v_cvt_pk_bf16_f32 v176, v152, v153
  v_mfma_f32_16x16x32_bf16 v[56:59], v[168:171], v[100:103], v[56:59]
  ds_read_b128 v[132:135], v187 offset:14336
  v_cvt_pk_bf16_f32 v177, v154, v155
  s_barrier
  v_mfma_f32_16x16x32_bf16 v[60:63], v[172:175], v[100:103], v[60:63]
  ds_read_b128 v[144:147], v192 offset:384
  v_cvt_pk_bf16_f32 v178, v156, v157
  v_mfma_f32_16x16x32_bf16 v[52:55], v[172:175], v[96:99], v[52:55]
  ds_read_b64_tr_b16 v[136:137], v190 offset:32768
  v_cvt_pk_bf16_f32 v179, v158, v159
  v_mfma_f32_16x16x32_bf16 v[44:47], v[172:175], v[92:95], v[44:47]
  ds_read_b64_tr_b16 v[138:139], v190 offset:33792
  v_cvt_pk_bf16_f32 v180, v160, v161
  v_mfma_f32_16x16x32_bf16 v[36:39], v[172:175], v[88:91], v[36:39]
  ds_read_b64_tr_b16 v[140:141], v191 offset:32768
  v_cvt_pk_bf16_f32 v181, v162, v163
  v_mfma_f32_16x16x32_bf16 v[28:31], v[172:175], v[84:87], v[28:31]
  ds_read_b64_tr_b16 v[142:143], v191 offset:33792
  v_cvt_pk_bf16_f32 v182, v164, v165
  v_mfma_f32_16x16x32_bf16 v[20:23], v[172:175], v[80:83], v[20:23]
  ds_read_b128 v[148:151], v193 offset:384
  v_cvt_pk_bf16_f32 v183, v166, v167
  v_mfma_f32_16x16x32_bf16 v[12:15], v[172:175], v[76:79], v[12:15]
  v_mfma_f32_16x16x32_bf16 v[4:7], v[172:175], v[72:75], v[4:7]
  s_waitcnt lgkmcnt(5)
  v_mfma_f32_16x16x32_bf16 v[0:3], v[176:179], v[104:107], v[0:3]
  ds_read_b128 v[72:75], v186 offset:32768
  v_and_b32 v144, v144, v250
  v_mfma_f32_16x16x32_bf16 v[8:11], v[176:179], v[108:111], v[8:11]
  ds_read_b128 v[76:79], v186 offset:34816
  v_and_b32 v145, v145, v251
  v_mfma_f32_16x16x32_bf16 v[64:67], v[176:179], v[244:247], v[64:67]
  v_mfma_f32_16x16x32_bf16 v[68:71], v[180:183], v[244:247], v[68:71]
  v_mfma_f32_16x16x32_bf16 v[16:19], v[176:179], v[112:115], v[16:19]
  ds_read_b128 v[80:83], v186 offset:36864
  v_and_b32 v146, v146, v250
  v_mfma_f32_16x16x32_bf16 v[24:27], v[176:179], v[116:119], v[24:27]
  ds_read_b128 v[84:87], v186 offset:38912
  v_and_b32 v147, v147, v251
  v_mfma_f32_16x16x32_bf16 v[32:35], v[176:179], v[120:123], v[32:35]
  ds_read_b128 v[88:91], v186 offset:40960
  s_waitcnt lgkmcnt(5)
  v_mfma_f32_4x4x4_16b_bf16 v[152:155], v[144:145], v[136:137], 0
  v_mfma_f32_4x4x4_16b_bf16 v[156:159], v[146:147], v[138:139], 0
  v_mfma_f32_4x4x4_16b_bf16 v[160:163], v[144:145], v[140:141], 0
  v_mfma_f32_4x4x4_16b_bf16 v[164:167], v[146:147], v[142:143], 0
  v_mfma_f32_16x16x32_bf16 v[40:43], v[176:179], v[124:127], v[40:43]
  ds_read_b128 v[92:95], v186 offset:43008
  v_mfma_f32_16x16x32_bf16 v[64:67], v[136:139], v[148:151], v[64:67]
  v_mfma_f32_16x16x32_bf16 v[68:71], v[140:143], v[148:151], v[68:71]
  v_mfma_f32_16x16x32_bf16 v[48:51], v[176:179], v[128:131], v[48:51]
  ds_read_b128 v[96:99], v186 offset:45056
  v_cvt_pk_bf16_f32 v168, v152, v153
  v_mfma_f32_16x16x32_bf16 v[56:59], v[176:179], v[132:135], v[56:59]
  ds_read_b128 v[100:103], v186 offset:47104
  v_cvt_pk_bf16_f32 v169, v154, v155
  v_mfma_f32_16x16x32_bf16 v[60:63], v[180:183], v[132:135], v[60:63]
  ds_read_b128 v[144:147], v192 offset:448
  v_cvt_pk_bf16_f32 v170, v156, v157
  v_mfma_f32_16x16x32_bf16 v[52:55], v[180:183], v[128:131], v[52:55]
  ds_read_b64_tr_b16 v[136:137], v190 offset:40960
  v_cvt_pk_bf16_f32 v171, v158, v159
  v_mfma_f32_16x16x32_bf16 v[44:47], v[180:183], v[124:127], v[44:47]
  ds_read_b64_tr_b16 v[138:139], v190 offset:41984
  v_cvt_pk_bf16_f32 v172, v160, v161
  v_mfma_f32_16x16x32_bf16 v[36:39], v[180:183], v[120:123], v[36:39]
  ds_read_b64_tr_b16 v[140:141], v191 offset:40960
  v_cvt_pk_bf16_f32 v173, v162, v163
  v_mfma_f32_16x16x32_bf16 v[28:31], v[180:183], v[116:119], v[28:31]
  ds_read_b64_tr_b16 v[142:143], v191 offset:41984
  v_cvt_pk_bf16_f32 v174, v164, v165
  v_mfma_f32_16x16x32_bf16 v[20:23], v[180:183], v[112:115], v[20:23]
  ds_read_b128 v[148:151], v193 offset:448
  v_cvt_pk_bf16_f32 v175, v166, v167
  v_mfma_f32_16x16x32_bf16 v[12:15], v[180:183], v[108:111], v[12:15]
  v_mfma_f32_16x16x32_bf16 v[4:7], v[180:183], v[104:107], v[4:7]
  s_waitcnt lgkmcnt(5)
  v_mfma_f32_16x16x32_bf16 v[0:3], v[168:171], v[72:75], v[0:3]
  ds_read_b128 v[104:107], v187 offset:32768
  v_and_b32 v144, v144, v250
  v_mfma_f32_16x16x32_bf16 v[8:11], v[168:171], v[76:79], v[8:11]
  ds_read_b128 v[108:111], v187 offset:34816
  v_and_b32 v145, v145, v251
  v_mfma_f32_16x16x32_bf16 v[64:67], v[168:171], v[244:247], v[64:67]
  v_mfma_f32_16x16x32_bf16 v[68:71], v[172:175], v[244:247], v[68:71]
  v_mfma_f32_16x16x32_bf16 v[16:19], v[168:171], v[80:83], v[16:19]
  ds_read_b128 v[112:115], v187 offset:36864
  v_and_b32 v146, v146, v250
  v_mfma_f32_16x16x32_bf16 v[24:27], v[168:171], v[84:87], v[24:27]
  ds_read_b128 v[116:119], v187 offset:38912
  v_and_b32 v147, v147, v251
  v_mfma_f32_16x16x32_bf16 v[32:35], v[168:171], v[88:91], v[32:35]
  ds_read_b128 v[120:123], v187 offset:40960
  s_waitcnt lgkmcnt(5)
  v_mfma_f32_4x4x4_16b_bf16 v[152:155], v[144:145], v[136:137], 0
  v_mfma_f32_4x4x4_16b_bf16 v[156:159], v[146:147], v[138:139], 0
  v_mfma_f32_4x4x4_16b_bf16 v[160:163], v[144:145], v[140:141], 0
  v_mfma_f32_4x4x4_16b_bf16 v[164:167], v[146:147], v[142:143], 0
  v_mfma_f32_16x16x32_bf16 v[40:43], v[168:171], v[92:95], v[40:43]
  ds_read_b128 v[124:127], v187 offset:43008
  v_mfma_f32_16x16x32_bf16 v[64:67], v[136:139], v[148:151], v[64:67]
  v_mfma_f32_16x16x32_bf16 v[68:71], v[140:143], v[148:151], v[68:71]
  v_mfma_f32_16x16x32_bf16 v[48:51], v[168:171], v[96:99], v[48:51]
  ds_read_b128 v[128:131], v187 offset:45056
  v_cvt_pk_bf16_f32 v176, v152, v153
  v_mfma_f32_16x16x32_bf16 v[56:59], v[168:171], v[100:103], v[56:59]
  ds_read_b128 v[132:135], v187 offset:47104
  v_cvt_pk_bf16_f32 v177, v154, v155
  s_barrier
  v_mfma_f32_16x16x32_bf16 v[60:63], v[172:175], v[100:103], v[60:63]
  ds_read_b128 v[144:147], v192 offset:512
  v_cvt_pk_bf16_f32 v178, v156, v157
  v_mfma_f32_16x16x32_bf16 v[52:55], v[172:175], v[96:99], v[52:55]
  ds_read_b64_tr_b16 v[136:137], v188 offset:0
  v_cvt_pk_bf16_f32 v179, v158, v159
  v_mfma_f32_16x16x32_bf16 v[44:47], v[172:175], v[92:95], v[44:47]
  ds_read_b64_tr_b16 v[138:139], v188 offset:1024
  v_cvt_pk_bf16_f32 v180, v160, v161
  v_mfma_f32_16x16x32_bf16 v[36:39], v[172:175], v[88:91], v[36:39]
  ds_read_b64_tr_b16 v[140:141], v189 offset:0
  v_cvt_pk_bf16_f32 v181, v162, v163
  v_mfma_f32_16x16x32_bf16 v[28:31], v[172:175], v[84:87], v[28:31]
  ds_read_b64_tr_b16 v[142:143], v189 offset:1024
  v_cvt_pk_bf16_f32 v182, v164, v165
  v_mfma_f32_16x16x32_bf16 v[20:23], v[172:175], v[80:83], v[20:23]
  v_cvt_pk_bf16_f32 v183, v166, v167
  v_mfma_f32_16x16x32_bf16 v[12:15], v[172:175], v[76:79], v[12:15]
  v_mfma_f32_16x16x32_bf16 v[4:7], v[172:175], v[72:75], v[4:7]
  s_waitcnt lgkmcnt(4)
  v_mfma_f32_16x16x32_bf16 v[0:3], v[176:179], v[104:107], v[0:3]
  ds_read_b128 v[72:75], v184 offset:0
  v_and_b32 v144, v144, v250
  v_mfma_f32_16x16x32_bf16 v[8:11], v[176:179], v[108:111], v[8:11]
  ds_read_b128 v[76:79], v184 offset:2048
  v_and_b32 v145, v145, v251
  v_mfma_f32_16x16x32_bf16 v[64:67], v[176:179], v[244:247], v[64:67]
  v_mfma_f32_16x16x32_bf16 v[68:71], v[180:183], v[244:247], v[68:71]
  v_mfma_f32_16x16x32_bf16 v[16:19], v[176:179], v[112:115], v[16:19]
  ds_read_b128 v[80:83], v184 offset:4096
  v_and_b32 v146, v146, v250
  v_mfma_f32_16x16x32_bf16 v[24:27], v[176:179], v[116:119], v[24:27]
  ds_read_b128 v[84:87], v184 offset:6144
  v_and_b32 v147, v147, v251
  v_mfma_f32_16x16x32_bf16 v[32:35], v[176:179], v[120:123], v[32:35]
  ds_read_b128 v[88:91], v184 offset:8192
  s_waitcnt lgkmcnt(5)
  v_mfma_f32_4x4x4_16b_bf16 v[152:155], v[144:145], v[136:137], 0
  v_mfma_f32_4x4x4_16b_bf16 v[156:159], v[146:147], v[138:139], 0
  v_mfma_f32_4x4x4_16b_bf16 v[160:163], v[144:145], v[140:141], 0
  v_mfma_f32_4x4x4_16b_bf16 v[164:167], v[146:147], v[142:143], 0
  v_mfma_f32_16x16x32_bf16 v[40:43], v[176:179], v[124:127], v[40:43]
  ds_read_b128 v[92:95], v184 offset:10240
  v_mfma_f32_16x16x32_bf16 v[48:51], v[176:179], v[128:131], v[48:51]
  ds_read_b128 v[96:99], v184 offset:12288
  v_cvt_pk_bf16_f32 v168, v152, v153
  v_mfma_f32_16x16x32_bf16 v[56:59], v[176:179], v[132:135], v[56:59]
  ds_read_b128 v[100:103], v184 offset:14336
  v_cvt_pk_bf16_f32 v169, v154, v155
  v_mfma_f32_16x16x32_bf16 v[60:63], v[180:183], v[132:135], v[60:63]
  ds_read_b128 v[144:147], v192 offset:576
  v_cvt_pk_bf16_f32 v170, v156, v157
  v_mfma_f32_16x16x32_bf16 v[52:55], v[180:183], v[128:131], v[52:55]
  ds_read_b64_tr_b16 v[136:137], v188 offset:8192
  v_cvt_pk_bf16_f32 v171, v158, v159
  v_mfma_f32_16x16x32_bf16 v[44:47], v[180:183], v[124:127], v[44:47]
  ds_read_b64_tr_b16 v[138:139], v188 offset:9216
  v_cvt_pk_bf16_f32 v172, v160, v161
  v_mfma_f32_16x16x32_bf16 v[36:39], v[180:183], v[120:123], v[36:39]
  ds_read_b64_tr_b16 v[140:141], v189 offset:8192
  v_cvt_pk_bf16_f32 v173, v162, v163
  v_mfma_f32_16x16x32_bf16 v[28:31], v[180:183], v[116:119], v[28:31]
  ds_read_b64_tr_b16 v[142:143], v189 offset:9216
  v_cvt_pk_bf16_f32 v174, v164, v165
  v_mfma_f32_16x16x32_bf16 v[20:23], v[180:183], v[112:115], v[20:23]
  v_cvt_pk_bf16_f32 v175, v166, v167
  v_mfma_f32_16x16x32_bf16 v[12:15], v[180:183], v[108:111], v[12:15]
  v_mfma_f32_16x16x32_bf16 v[4:7], v[180:183], v[104:107], v[4:7]
  s_waitcnt lgkmcnt(4)
  v_mfma_f32_16x16x32_bf16 v[0:3], v[168:171], v[72:75], v[0:3]
  ds_read_b128 v[104:107], v185 offset:0
  v_and_b32 v144, v144, v250
  v_mfma_f32_16x16x32_bf16 v[8:11], v[168:171], v[76:79], v[8:11]
  ds_read_b128 v[108:111], v185 offset:2048
  v_and_b32 v145, v145, v251
  v_mfma_f32_16x16x32_bf16 v[16:19], v[168:171], v[80:83], v[16:19]
  ds_read_b128 v[112:115], v185 offset:4096
  v_and_b32 v146, v146, v250
  v_mfma_f32_16x16x32_bf16 v[24:27], v[168:171], v[84:87], v[24:27]
  ds_read_b128 v[116:119], v185 offset:6144
  v_and_b32 v147, v147, v251
  v_mfma_f32_16x16x32_bf16 v[32:35], v[168:171], v[88:91], v[32:35]
  ds_read_b128 v[120:123], v185 offset:8192
  s_waitcnt lgkmcnt(5)
  v_mfma_f32_4x4x4_16b_bf16 v[152:155], v[144:145], v[136:137], 0
  v_mfma_f32_4x4x4_16b_bf16 v[156:159], v[146:147], v[138:139], 0
  v_mfma_f32_4x4x4_16b_bf16 v[160:163], v[144:145], v[140:141], 0
  v_mfma_f32_4x4x4_16b_bf16 v[164:167], v[146:147], v[142:143], 0
  v_mfma_f32_16x16x32_bf16 v[40:43], v[168:171], v[92:95], v[40:43]
  ds_read_b128 v[124:127], v185 offset:10240
  v_mfma_f32_16x16x32_bf16 v[48:51], v[168:171], v[96:99], v[48:51]
  ds_read_b128 v[128:131], v185 offset:12288
  v_cvt_pk_bf16_f32 v176, v152, v153
  v_mfma_f32_16x16x32_bf16 v[56:59], v[168:171], v[100:103], v[56:59]
  ds_read_b128 v[132:135], v185 offset:14336
  v_cvt_pk_bf16_f32 v177, v154, v155
  s_barrier
  v_mfma_f32_16x16x32_bf16 v[60:63], v[172:175], v[100:103], v[60:63]
  ds_read_b128 v[144:147], v192 offset:640
  v_cvt_pk_bf16_f32 v178, v156, v157
  v_mfma_f32_16x16x32_bf16 v[52:55], v[172:175], v[96:99], v[52:55]
  ds_read_b64_tr_b16 v[136:137], v188 offset:32768
  v_cvt_pk_bf16_f32 v179, v158, v159
  v_mfma_f32_16x16x32_bf16 v[44:47], v[172:175], v[92:95], v[44:47]
  ds_read_b64_tr_b16 v[138:139], v188 offset:33792
  v_cvt_pk_bf16_f32 v180, v160, v161
  v_mfma_f32_16x16x32_bf16 v[36:39], v[172:175], v[88:91], v[36:39]
  ds_read_b64_tr_b16 v[140:141], v189 offset:32768
  v_cvt_pk_bf16_f32 v181, v162, v163
  v_mfma_f32_16x16x32_bf16 v[28:31], v[172:175], v[84:87], v[28:31]
  ds_read_b64_tr_b16 v[142:143], v189 offset:33792
  v_cvt_pk_bf16_f32 v182, v164, v165
  v_mfma_f32_16x16x32_bf16 v[20:23], v[172:175], v[80:83], v[20:23]
  v_cvt_pk_bf16_f32 v183, v166, v167
  v_mfma_f32_16x16x32_bf16 v[12:15], v[172:175], v[76:79], v[12:15]
  ds_write_b128 v252, v[64:67]
  v_mfma_f32_16x16x32_bf16 v[4:7], v[172:175], v[72:75], v[4:7]
  ds_write_b128 v252, v[68:71] offset:64
  s_waitcnt lgkmcnt(6)
  v_mfma_f32_16x16x32_bf16 v[0:3], v[176:179], v[104:107], v[0:3]
  ds_read_b128 v[72:75], v184 offset:32768
  v_and_b32 v144, v144, v250
  v_mfma_f32_16x16x32_bf16 v[8:11], v[176:179], v[108:111], v[8:11]
  ds_read_b128 v[76:79], v184 offset:34816
  v_and_b32 v145, v145, v251
  v_mfma_f32_16x16x32_bf16 v[16:19], v[176:179], v[112:115], v[16:19]
  ds_read_b128 v[80:83], v184 offset:36864
  v_and_b32 v146, v146, v250
  v_mfma_f32_16x16x32_bf16 v[24:27], v[176:179], v[116:119], v[24:27]
  ds_read_b128 v[84:87], v184 offset:38912
  v_and_b32 v147, v147, v251
  v_mfma_f32_16x16x32_bf16 v[32:35], v[176:179], v[120:123], v[32:35]
  ds_read_b128 v[88:91], v184 offset:40960
  s_waitcnt lgkmcnt(5)
  v_mfma_f32_4x4x4_16b_bf16 v[152:155], v[144:145], v[136:137], 0
  v_mfma_f32_4x4x4_16b_bf16 v[156:159], v[146:147], v[138:139], 0
  v_mfma_f32_4x4x4_16b_bf16 v[160:163], v[144:145], v[140:141], 0
  v_mfma_f32_4x4x4_16b_bf16 v[164:167], v[146:147], v[142:143], 0
  v_mfma_f32_16x16x32_bf16 v[40:43], v[176:179], v[124:127], v[40:43]
  ds_read_b128 v[92:95], v184 offset:43008
  v_mfma_f32_16x16x32_bf16 v[48:51], v[176:179], v[128:131], v[48:51]
  ds_read_b128 v[96:99], v184 offset:45056
  v_cvt_pk_bf16_f32 v168, v152, v153
  v_mfma_f32_16x16x32_bf16 v[56:59], v[176:179], v[132:135], v[56:59]
  ds_read_b128 v[100:103], v184 offset:47104
  v_cvt_pk_bf16_f32 v169, v154, v155
  v_mfma_f32_16x16x32_bf16 v[60:63], v[180:183], v[132:135], v[60:63]
  ds_read_b128 v[144:147], v192 offset:704
  v_cvt_pk_bf16_f32 v170, v156, v157
  v_mfma_f32_16x16x32_bf16 v[52:55], v[180:183], v[128:131], v[52:55]
  ds_read_b64_tr_b16 v[136:137], v188 offset:40960
  v_cvt_pk_bf16_f32 v171, v158, v159
  v_mfma_f32_16x16x32_bf16 v[44:47], v[180:183], v[124:127], v[44:47]
  ds_read_b64_tr_b16 v[138:139], v188 offset:41984
  v_cvt_pk_bf16_f32 v172, v160, v161
  v_mfma_f32_16x16x32_bf16 v[36:39], v[180:183], v[120:123], v[36:39]
  ds_read_b64_tr_b16 v[140:141], v189 offset:40960
  v_cvt_pk_bf16_f32 v173, v162, v163
  v_mfma_f32_16x16x32_bf16 v[28:31], v[180:183], v[116:119], v[28:31]
  ds_read_b64_tr_b16 v[142:143], v189 offset:41984
  v_cvt_pk_bf16_f32 v174, v164, v165
  v_mfma_f32_16x16x32_bf16 v[20:23], v[180:183], v[112:115], v[20:23]
  v_cvt_pk_bf16_f32 v175, v166, v167
  v_mfma_f32_16x16x32_bf16 v[12:15], v[180:183], v[108:111], v[12:15]
  v_mfma_f32_16x16x32_bf16 v[4:7], v[180:183], v[104:107], v[4:7]
  s_waitcnt lgkmcnt(4)
  v_mfma_f32_16x16x32_bf16 v[0:3], v[168:171], v[72:75], v[0:3]
  ds_read_b128 v[104:107], v185 offset:32768
  v_and_b32 v144, v144, v250
  v_mfma_f32_16x16x32_bf16 v[8:11], v[168:171], v[76:79], v[8:11]
  ds_read_b128 v[108:111], v185 offset:34816
  v_and_b32 v145, v145, v251
  v_mfma_f32_16x16x32_bf16 v[16:19], v[168:171], v[80:83], v[16:19]
  ds_read_b128 v[112:115], v185 offset:36864
  v_and_b32 v146, v146, v250
  v_mfma_f32_16x16x32_bf16 v[24:27], v[168:171], v[84:87], v[24:27]
  ds_read_b128 v[116:119], v185 offset:38912
  v_and_b32 v147, v147, v251
  v_mfma_f32_16x16x32_bf16 v[32:35], v[168:171], v[88:91], v[32:35]
  ds_read_b128 v[120:123], v185 offset:40960
  s_waitcnt lgkmcnt(5)
  v_mfma_f32_4x4x4_16b_bf16 v[152:155], v[144:145], v[136:137], 0
  v_mfma_f32_4x4x4_16b_bf16 v[156:159], v[146:147], v[138:139], 0
  v_mfma_f32_4x4x4_16b_bf16 v[160:163], v[144:145], v[140:141], 0
  v_mfma_f32_4x4x4_16b_bf16 v[164:167], v[146:147], v[142:143], 0
  v_mfma_f32_16x16x32_bf16 v[40:43], v[168:171], v[92:95], v[40:43]
  ds_read_b128 v[124:127], v185 offset:43008
  v_mfma_f32_16x16x32_bf16 v[48:51], v[168:171], v[96:99], v[48:51]
  ds_read_b128 v[128:131], v185 offset:45056
  v_cvt_pk_bf16_f32 v176, v152, v153
  v_mfma_f32_16x16x32_bf16 v[56:59], v[168:171], v[100:103], v[56:59]
  ds_read_b128 v[132:135], v185 offset:47104
  v_cvt_pk_bf16_f32 v177, v154, v155
  s_barrier
  v_mfma_f32_16x16x32_bf16 v[60:63], v[172:175], v[100:103], v[60:63]
  ds_read_b128 v[144:147], v192 offset:768
  v_cvt_pk_bf16_f32 v178, v156, v157
  v_mfma_f32_16x16x32_bf16 v[52:55], v[172:175], v[96:99], v[52:55]
  ds_read_b64_tr_b16 v[136:137], v190 offset:0
  v_cvt_pk_bf16_f32 v179, v158, v159
  v_mfma_f32_16x16x32_bf16 v[44:47], v[172:175], v[92:95], v[44:47]
  ds_read_b64_tr_b16 v[138:139], v190 offset:1024
  v_cvt_pk_bf16_f32 v180, v160, v161
  v_mfma_f32_16x16x32_bf16 v[36:39], v[172:175], v[88:91], v[36:39]
  ds_read_b64_tr_b16 v[140:141], v191 offset:0
  v_cvt_pk_bf16_f32 v181, v162, v163
  v_mfma_f32_16x16x32_bf16 v[28:31], v[172:175], v[84:87], v[28:31]
  ds_read_b64_tr_b16 v[142:143], v191 offset:1024
  v_cvt_pk_bf16_f32 v182, v164, v165
  v_mfma_f32_16x16x32_bf16 v[20:23], v[172:175], v[80:83], v[20:23]
  v_cvt_pk_bf16_f32 v183, v166, v167
  v_mfma_f32_16x16x32_bf16 v[12:15], v[172:175], v[76:79], v[12:15]
  v_mfma_f32_16x16x32_bf16 v[4:7], v[172:175], v[72:75], v[4:7]
  s_waitcnt lgkmcnt(4)
  v_mfma_f32_16x16x32_bf16 v[0:3], v[176:179], v[104:107], v[0:3]
  ds_read_b128 v[72:75], v186 offset:0
  v_and_b32 v144, v144, v250
  v_mfma_f32_16x16x32_bf16 v[8:11], v[176:179], v[108:111], v[8:11]
  ds_read_b128 v[76:79], v186 offset:2048
  v_and_b32 v145, v145, v251
  v_mfma_f32_16x16x32_bf16 v[16:19], v[176:179], v[112:115], v[16:19]
  ds_read_b128 v[80:83], v186 offset:4096
  v_and_b32 v146, v146, v250
  v_mfma_f32_16x16x32_bf16 v[24:27], v[176:179], v[116:119], v[24:27]
  ds_read_b128 v[84:87], v186 offset:6144
  v_and_b32 v147, v147, v251
  v_mfma_f32_16x16x32_bf16 v[32:35], v[176:179], v[120:123], v[32:35]
  ds_read_b128 v[88:91], v186 offset:8192
  s_waitcnt lgkmcnt(5)
  v_mfma_f32_4x4x4_16b_bf16 v[152:155], v[144:145], v[136:137], 0
  v_mfma_f32_4x4x4_16b_bf16 v[156:159], v[146:147], v[138:139], 0
  v_mfma_f32_4x4x4_16b_bf16 v[160:163], v[144:145], v[140:141], 0
  v_mfma_f32_4x4x4_16b_bf16 v[164:167], v[146:147], v[142:143], 0
  v_mfma_f32_16x16x32_bf16 v[40:43], v[176:179], v[124:127], v[40:43]
  ds_read_b128 v[92:95], v186 offset:10240
  v_mfma_f32_16x16x32_bf16 v[48:51], v[176:179], v[128:131], v[48:51]
  ds_read_b128 v[96:99], v186 offset:12288
  v_cvt_pk_bf16_f32 v168, v152, v153
  v_mfma_f32_16x16x32_bf16 v[56:59], v[176:179], v[132:135], v[56:59]
  ds_read_b128 v[100:103], v186 offset:14336
  v_cvt_pk_bf16_f32 v169, v154, v155
  v_mfma_f32_16x16x32_bf16 v[60:63], v[180:183], v[132:135], v[60:63]
  ds_read_b128 v[144:147], v192 offset:832
  v_cvt_pk_bf16_f32 v170, v156, v157
  v_mfma_f32_16x16x32_bf16 v[52:55], v[180:183], v[128:131], v[52:55]
  ds_read_b64_tr_b16 v[136:137], v190 offset:8192
  v_cvt_pk_bf16_f32 v171, v158, v159
  v_mfma_f32_16x16x32_bf16 v[44:47], v[180:183], v[124:127], v[44:47]
  ds_read_b64_tr_b16 v[138:139], v190 offset:9216
  v_cvt_pk_bf16_f32 v172, v160, v161
  v_mfma_f32_16x16x32_bf16 v[36:39], v[180:183], v[120:123], v[36:39]
  ds_read_b64_tr_b16 v[140:141], v191 offset:8192
  v_cvt_pk_bf16_f32 v173, v162, v163
  v_mfma_f32_16x16x32_bf16 v[28:31], v[180:183], v[116:119], v[28:31]
  ds_read_b64_tr_b16 v[142:143], v191 offset:9216
  v_cvt_pk_bf16_f32 v174, v164, v165
  v_mfma_f32_16x16x32_bf16 v[20:23], v[180:183], v[112:115], v[20:23]
  v_cvt_pk_bf16_f32 v175, v166, v167
  v_mfma_f32_16x16x32_bf16 v[12:15], v[180:183], v[108:111], v[12:15]
  v_mfma_f32_16x16x32_bf16 v[4:7], v[180:183], v[104:107], v[4:7]
  s_waitcnt lgkmcnt(4)
  v_mfma_f32_16x16x32_bf16 v[0:3], v[168:171], v[72:75], v[0:3]
  ds_read_b128 v[104:107], v187 offset:0
  v_and_b32 v144, v144, v250
  v_mfma_f32_16x16x32_bf16 v[8:11], v[168:171], v[76:79], v[8:11]
  ds_read_b128 v[108:111], v187 offset:2048
  v_and_b32 v145, v145, v251
  v_mfma_f32_16x16x32_bf16 v[16:19], v[168:171], v[80:83], v[16:19]
  ds_read_b128 v[112:115], v187 offset:4096
  v_and_b32 v146, v146, v250
  v_mfma_f32_16x16x32_bf16 v[24:27], v[168:171], v[84:87], v[24:27]
  ds_read_b128 v[116:119], v187 offset:6144
  v_and_b32 v147, v147, v251
  v_mfma_f32_16x16x32_bf16 v[32:35], v[168:171], v[88:91], v[32:35]
  ds_read_b128 v[120:123], v187 offset:8192
  s_waitcnt lgkmcnt(5)
  v_mfma_f32_4x4x4_16b_bf16 v[152:155], v[144:145], v[136:137], 0
  v_mfma_f32_4x4x4_16b_bf16 v[156:159], v[146:147], v[138:139], 0
  v_mfma_f32_4x4x4_16b_bf16 v[160:163], v[144:145], v[140:141], 0
  v_mfma_f32_4x4x4_16b_bf16 v[164:167], v[146:147], v[142:143], 0
  v_mfma_f32_16x16x32_bf16 v[40:43], v[168:171], v[92:95], v[40:43]
  ds_read_b128 v[124:127], v187 offset:10240
  v_mfma_f32_16x16x32_bf16 v[48:51], v[168:171], v[96:99], v[48:51]
  ds_read_b128 v[128:131], v187 offset:12288
  v_cvt_pk_bf16_f32 v176, v152, v153
  v_mfma_f32_16x16x32_bf16 v[56:59], v[168:171], v[100:103], v[56:59]
  ds_read_b128 v[132:135], v187 offset:14336
  v_cvt_pk_bf16_f32 v177, v154, v155
  s_barrier
  v_mfma_f32_16x16x32_bf16 v[60:63], v[172:175], v[100:103], v[60:63]
  ds_read_b128 v[144:147], v192 offset:896
  v_cvt_pk_bf16_f32 v178, v156, v157
  v_mfma_f32_16x16x32_bf16 v[52:55], v[172:175], v[96:99], v[52:55]
  ds_read_b64_tr_b16 v[136:137], v190 offset:32768
  v_cvt_pk_bf16_f32 v179, v158, v159
  v_mfma_f32_16x16x32_bf16 v[44:47], v[172:175], v[92:95], v[44:47]
  ds_read_b64_tr_b16 v[138:139], v190 offset:33792
  v_cvt_pk_bf16_f32 v180, v160, v161
  v_mfma_f32_16x16x32_bf16 v[36:39], v[172:175], v[88:91], v[36:39]
  ds_read_b64_tr_b16 v[140:141], v191 offset:32768
  v_cvt_pk_bf16_f32 v181, v162, v163
  v_mfma_f32_16x16x32_bf16 v[28:31], v[172:175], v[84:87], v[28:31]
  ds_read_b64_tr_b16 v[142:143], v191 offset:33792
  v_cvt_pk_bf16_f32 v182, v164, v165
  v_mfma_f32_16x16x32_bf16 v[20:23], v[172:175], v[80:83], v[20:23]
  v_cvt_pk_bf16_f32 v183, v166, v167
  v_mfma_f32_16x16x32_bf16 v[12:15], v[172:175], v[76:79], v[12:15]
  v_mfma_f32_16x16x32_bf16 v[4:7], v[172:175], v[72:75], v[4:7]
  s_waitcnt lgkmcnt(4)
  v_mfma_f32_16x16x32_bf16 v[0:3], v[176:179], v[104:107], v[0:3]
  ds_read_b128 v[72:75], v186 offset:32768
  v_and_b32 v144, v144, v250
  v_mfma_f32_16x16x32_bf16 v[8:11], v[176:179], v[108:111], v[8:11]
  ds_read_b128 v[76:79], v186 offset:34816
  v_and_b32 v145, v145, v251
  v_mfma_f32_16x16x32_bf16 v[16:19], v[176:179], v[112:115], v[16:19]
  ds_read_b128 v[80:83], v186 offset:36864
  v_and_b32 v146, v146, v250
  v_mfma_f32_16x16x32_bf16 v[24:27], v[176:179], v[116:119], v[24:27]
  ds_read_b128 v[84:87], v186 offset:38912
  v_and_b32 v147, v147, v251
  v_mfma_f32_16x16x32_bf16 v[32:35], v[176:179], v[120:123], v[32:35]
  ds_read_b128 v[88:91], v186 offset:40960
  s_waitcnt lgkmcnt(5)
  v_mfma_f32_4x4x4_16b_bf16 v[152:155], v[144:145], v[136:137], 0
  v_mfma_f32_4x4x4_16b_bf16 v[156:159], v[146:147], v[138:139], 0
  v_mfma_f32_4x4x4_16b_bf16 v[160:163], v[144:145], v[140:141], 0
  v_mfma_f32_4x4x4_16b_bf16 v[164:167], v[146:147], v[142:143], 0
  v_mfma_f32_16x16x32_bf16 v[40:43], v[176:179], v[124:127], v[40:43]
  ds_read_b128 v[92:95], v186 offset:43008
  v_mfma_f32_16x16x32_bf16 v[48:51], v[176:179], v[128:131], v[48:51]
  ds_read_b128 v[96:99], v186 offset:45056
  v_cvt_pk_bf16_f32 v168, v152, v153
  v_mfma_f32_16x16x32_bf16 v[56:59], v[176:179], v[132:135], v[56:59]
  ds_read_b128 v[100:103], v186 offset:47104
  v_cvt_pk_bf16_f32 v169, v154, v155
  v_mfma_f32_16x16x32_bf16 v[60:63], v[180:183], v[132:135], v[60:63]
  ds_read_b128 v[144:147], v192 offset:960
  v_cvt_pk_bf16_f32 v170, v156, v157
  v_mfma_f32_16x16x32_bf16 v[52:55], v[180:183], v[128:131], v[52:55]
  ds_read_b64_tr_b16 v[136:137], v190 offset:40960
  v_cvt_pk_bf16_f32 v171, v158, v159
  v_mfma_f32_16x16x32_bf16 v[44:47], v[180:183], v[124:127], v[44:47]
  ds_read_b64_tr_b16 v[138:139], v190 offset:41984
  v_cvt_pk_bf16_f32 v172, v160, v161
  v_mfma_f32_16x16x32_bf16 v[36:39], v[180:183], v[120:123], v[36:39]
  ds_read_b64_tr_b16 v[140:141], v191 offset:40960
  v_cvt_pk_bf16_f32 v173, v162, v163
  v_mfma_f32_16x16x32_bf16 v[28:31], v[180:183], v[116:119], v[28:31]
  ds_read_b64_tr_b16 v[142:143], v191 offset:41984
  v_cvt_pk_bf16_f32 v174, v164, v165
  v_mfma_f32_16x16x32_bf16 v[20:23], v[180:183], v[112:115], v[20:23]
  v_cvt_pk_bf16_f32 v175, v166, v167
  v_mfma_f32_16x16x32_bf16 v[12:15], v[180:183], v[108:111], v[12:15]
  v_mfma_f32_16x16x32_bf16 v[4:7], v[180:183], v[104:107], v[4:7]
  s_waitcnt lgkmcnt(4)
  v_mfma_f32_16x16x32_bf16 v[0:3], v[168:171], v[72:75], v[0:3]
  ds_read_b128 v[104:107], v187 offset:32768
  v_and_b32 v144, v144, v250
  v_mfma_f32_16x16x32_bf16 v[8:11], v[168:171], v[76:79], v[8:11]
  ds_read_b128 v[108:111], v187 offset:34816
  v_and_b32 v145, v145, v251
  v_mfma_f32_16x16x32_bf16 v[16:19], v[168:171], v[80:83], v[16:19]
  ds_read_b128 v[112:115], v187 offset:36864
  v_and_b32 v146, v146, v250
  v_mfma_f32_16x16x32_bf16 v[24:27], v[168:171], v[84:87], v[24:27]
  ds_read_b128 v[116:119], v187 offset:38912
  v_and_b32 v147, v147, v251
  v_mfma_f32_16x16x32_bf16 v[32:35], v[168:171], v[88:91], v[32:35]
  ds_read_b128 v[120:123], v187 offset:40960
  s_waitcnt lgkmcnt(5)
  v_mfma_f32_4x4x4_16b_bf16 v[152:155], v[144:145], v[136:137], 0
  v_mfma_f32_4x4x4_16b_bf16 v[156:159], v[146:147], v[138:139], 0
  v_mfma_f32_4x4x4_16b_bf16 v[160:163], v[144:145], v[140:141], 0
  v_mfma_f32_4x4x4_16b_bf16 v[164:167], v[146:147], v[142:143], 0
  v_mfma_f32_16x16x32_bf16 v[40:43], v[168:171], v[92:95], v[40:43]
  ds_read_b128 v[124:127], v187 offset:43008
  v_mfma_f32_16x16x32_bf16 v[48:51], v[168:171], v[96:99], v[48:51]
  ds_read_b128 v[128:131], v187 offset:45056
  v_cvt_pk_bf16_f32 v176, v152, v153
  v_mfma_f32_16x16x32_bf16 v[56:59], v[168:171], v[100:103], v[56:59]
  ds_read_b128 v[132:135], v187 offset:47104
  v_cvt_pk_bf16_f32 v177, v154, v155
  s_barrier
  v_mfma_f32_16x16x32_bf16 v[60:63], v[172:175], v[100:103], v[60:63]
  ds_read_b128 v[144:147], v192 offset:1024
  v_cvt_pk_bf16_f32 v178, v156, v157
  v_mfma_f32_16x16x32_bf16 v[52:55], v[172:175], v[96:99], v[52:55]
  ds_read_b64_tr_b16 v[136:137], v188 offset:0
  v_cvt_pk_bf16_f32 v179, v158, v159
  v_mfma_f32_16x16x32_bf16 v[44:47], v[172:175], v[92:95], v[44:47]
  ds_read_b64_tr_b16 v[138:139], v188 offset:1024
  v_cvt_pk_bf16_f32 v180, v160, v161
  v_mfma_f32_16x16x32_bf16 v[36:39], v[172:175], v[88:91], v[36:39]
  ds_read_b64_tr_b16 v[140:141], v189 offset:0
  v_cvt_pk_bf16_f32 v181, v162, v163
  v_mfma_f32_16x16x32_bf16 v[28:31], v[172:175], v[84:87], v[28:31]
  ds_read_b64_tr_b16 v[142:143], v189 offset:1024
  v_cvt_pk_bf16_f32 v182, v164, v165
  v_mfma_f32_16x16x32_bf16 v[20:23], v[172:175], v[80:83], v[20:23]
  v_cvt_pk_bf16_f32 v183, v166, v167
  v_mfma_f32_16x16x32_bf16 v[12:15], v[172:175], v[76:79], v[12:15]
  v_mfma_f32_16x16x32_bf16 v[4:7], v[172:175], v[72:75], v[4:7]
  s_waitcnt lgkmcnt(4)
  v_mfma_f32_16x16x32_bf16 v[0:3], v[176:179], v[104:107], v[0:3]
  ds_read_b128 v[72:75], v184 offset:0
  v_and_b32 v144, v144, v250
  v_mfma_f32_16x16x32_bf16 v[8:11], v[176:179], v[108:111], v[8:11]
  ds_read_b128 v[76:79], v184 offset:2048
  v_and_b32 v145, v145, v251
  v_mfma_f32_16x16x32_bf16 v[16:19], v[176:179], v[112:115], v[16:19]
  ds_read_b128 v[80:83], v184 offset:4096
  v_and_b32 v146, v146, v250
  v_mfma_f32_16x16x32_bf16 v[24:27], v[176:179], v[116:119], v[24:27]
  ds_read_b128 v[84:87], v184 offset:6144
  v_and_b32 v147, v147, v251
  v_mfma_f32_16x16x32_bf16 v[32:35], v[176:179], v[120:123], v[32:35]
  ds_read_b128 v[88:91], v184 offset:8192
  s_waitcnt lgkmcnt(5)
  v_mfma_f32_4x4x4_16b_bf16 v[152:155], v[144:145], v[136:137], 0
  v_mfma_f32_4x4x4_16b_bf16 v[156:159], v[146:147], v[138:139], 0
  v_mfma_f32_4x4x4_16b_bf16 v[160:163], v[144:145], v[140:141], 0
  v_mfma_f32_4x4x4_16b_bf16 v[164:167], v[146:147], v[142:143], 0
  v_mfma_f32_16x16x32_bf16 v[40:43], v[176:179], v[124:127], v[40:43]
  ds_read_b128 v[92:95], v184 offset:10240
  v_mfma_f32_16x16x32_bf16 v[48:51], v[176:179], v[128:131], v[48:51]
  ds_read_b128 v[96:99], v184 offset:12288
  v_cvt_pk_bf16_f32 v168, v152, v153
  v_mfma_f32_16x16x32_bf16 v[56:59], v[176:179], v[132:135], v[56:59]
  ds_read_b128 v[100:103], v184 offset:14336
  v_cvt_pk_bf16_f32 v169, v154, v155
  v_mfma_f32_16x16x32_bf16 v[60:63], v[180:183], v[132:135], v[60:63]
  ds_read_b128 v[144:147], v192 offset:1088
  v_cvt_pk_bf16_f32 v170, v156, v157
  v_mfma_f32_16x16x32_bf16 v[52:55], v[180:183], v[128:131], v[52:55]
  ds_read_b64_tr_b16 v[136:137], v188 offset:8192
  v_cvt_pk_bf16_f32 v171, v158, v159
  v_mfma_f32_16x16x32_bf16 v[44:47], v[180:183], v[124:127], v[44:47]
  ds_read_b64_tr_b16 v[138:139], v188 offset:9216
  v_cvt_pk_bf16_f32 v172, v160, v161
  v_mfma_f32_16x16x32_bf16 v[36:39], v[180:183], v[120:123], v[36:39]
  ds_read_b64_tr_b16 v[140:141], v189 offset:8192
  v_cvt_pk_bf16_f32 v173, v162, v163
  v_mfma_f32_16x16x32_bf16 v[28:31], v[180:183], v[116:119], v[28:31]
  ds_read_b64_tr_b16 v[142:143], v189 offset:9216
  v_cvt_pk_bf16_f32 v174, v164, v165
  v_mfma_f32_16x16x32_bf16 v[20:23], v[180:183], v[112:115], v[20:23]
  v_cvt_pk_bf16_f32 v175, v166, v167
  v_mfma_f32_16x16x32_bf16 v[12:15], v[180:183], v[108:111], v[12:15]
  v_mfma_f32_16x16x32_bf16 v[4:7], v[180:183], v[104:107], v[4:7]
  s_waitcnt lgkmcnt(4)
  v_mfma_f32_16x16x32_bf16 v[0:3], v[168:171], v[72:75], v[0:3]
  ds_read_b128 v[104:107], v185 offset:0
  v_and_b32 v144, v144, v250
  v_mfma_f32_16x16x32_bf16 v[8:11], v[168:171], v[76:79], v[8:11]
  ds_read_b128 v[108:111], v185 offset:2048
  v_and_b32 v145, v145, v251
  v_mfma_f32_16x16x32_bf16 v[16:19], v[168:171], v[80:83], v[16:19]
  ds_read_b128 v[112:115], v185 offset:4096
  v_and_b32 v146, v146, v250
  v_mfma_f32_16x16x32_bf16 v[24:27], v[168:171], v[84:87], v[24:27]
  ds_read_b128 v[116:119], v185 offset:6144
  v_and_b32 v147, v147, v251
  v_mfma_f32_16x16x32_bf16 v[32:35], v[168:171], v[88:91], v[32:35]
  ds_read_b128 v[120:123], v185 offset:8192
  s_waitcnt lgkmcnt(5)
  v_mfma_f32_4x4x4_16b_bf16 v[152:155], v[144:145], v[136:137], 0
  v_mfma_f32_4x4x4_16b_bf16 v[156:159], v[146:147], v[138:139], 0
  v_mfma_f32_4x4x4_16b_bf16 v[160:163], v[144:145], v[140:141], 0
  v_mfma_f32_4x4x4_16b_bf16 v[164:167], v[146:147], v[142:143], 0
  v_mfma_f32_16x16x32_bf16 v[40:43], v[168:171], v[92:95], v[40:43]
  ds_read_b128 v[124:127], v185 offset:10240
  v_mfma_f32_16x16x32_bf16 v[48:51], v[168:171], v[96:99], v[48:51]
  ds_read_b128 v[128:131], v185 offset:12288
  v_cvt_pk_bf16_f32 v176, v152, v153
  v_mfma_f32_16x16x32_bf16 v[56:59], v[168:171], v[100:103], v[56:59]
  ds_read_b128 v[132:135], v185 offset:14336
  v_cvt_pk_bf16_f32 v177, v154, v155
  s_barrier
  v_mfma_f32_16x16x32_bf16 v[60:63], v[172:175], v[100:103], v[60:63]
  ds_read_b128 v[144:147], v192 offset:1152
  v_cvt_pk_bf16_f32 v178, v156, v157
  v_mfma_f32_16x16x32_bf16 v[52:55], v[172:175], v[96:99], v[52:55]
  ds_read_b64_tr_b16 v[136:137], v188 offset:32768
  v_cvt_pk_bf16_f32 v179, v158, v159
  v_mfma_f32_16x16x32_bf16 v[44:47], v[172:175], v[92:95], v[44:47]
  ds_read_b64_tr_b16 v[138:139], v188 offset:33792
  v_cvt_pk_bf16_f32 v180, v160, v161
  v_mfma_f32_16x16x32_bf16 v[36:39], v[172:175], v[88:91], v[36:39]
  ds_read_b64_tr_b16 v[140:141], v189 offset:32768
  v_cvt_pk_bf16_f32 v181, v162, v163
  v_mfma_f32_16x16x32_bf16 v[28:31], v[172:175], v[84:87], v[28:31]
  ds_read_b64_tr_b16 v[142:143], v189 offset:33792
  v_cvt_pk_bf16_f32 v182, v164, v165
  v_mfma_f32_16x16x32_bf16 v[20:23], v[172:175], v[80:83], v[20:23]
  v_cvt_pk_bf16_f32 v183, v166, v167
  v_mfma_f32_16x16x32_bf16 v[12:15], v[172:175], v[76:79], v[12:15]
  v_mfma_f32_16x16x32_bf16 v[4:7], v[172:175], v[72:75], v[4:7]
  s_waitcnt lgkmcnt(4)
  v_mfma_f32_16x16x32_bf16 v[0:3], v[176:179], v[104:107], v[0:3]
  ds_read_b128 v[72:75], v184 offset:32768
  v_and_b32 v144, v144, v250
  v_mfma_f32_16x16x32_bf16 v[8:11], v[176:179], v[108:111], v[8:11]
  ds_read_b128 v[76:79], v184 offset:34816
  v_and_b32 v145, v145, v251
  v_mfma_f32_16x16x32_bf16 v[16:19], v[176:179], v[112:115], v[16:19]
  ds_read_b128 v[80:83], v184 offset:36864
  v_and_b32 v146, v146, v250
  v_mfma_f32_16x16x32_bf16 v[24:27], v[176:179], v[116:119], v[24:27]
  ds_read_b128 v[84:87], v184 offset:38912
  v_and_b32 v147, v147, v251
  v_mfma_f32_16x16x32_bf16 v[32:35], v[176:179], v[120:123], v[32:35]
  ds_read_b128 v[88:91], v184 offset:40960
  s_waitcnt lgkmcnt(5)
  v_mfma_f32_4x4x4_16b_bf16 v[152:155], v[144:145], v[136:137], 0
  v_mfma_f32_4x4x4_16b_bf16 v[156:159], v[146:147], v[138:139], 0
  v_mfma_f32_4x4x4_16b_bf16 v[160:163], v[144:145], v[140:141], 0
  v_mfma_f32_4x4x4_16b_bf16 v[164:167], v[146:147], v[142:143], 0
  v_mfma_f32_16x16x32_bf16 v[40:43], v[176:179], v[124:127], v[40:43]
  ds_read_b128 v[92:95], v184 offset:43008
  v_mfma_f32_16x16x32_bf16 v[48:51], v[176:179], v[128:131], v[48:51]
  ds_read_b128 v[96:99], v184 offset:45056
  v_cvt_pk_bf16_f32 v168, v152, v153
  v_mfma_f32_16x16x32_bf16 v[56:59], v[176:179], v[132:135], v[56:59]
  ds_read_b128 v[100:103], v184 offset:47104
  v_cvt_pk_bf16_f32 v169, v154, v155
  v_mfma_f32_16x16x32_bf16 v[60:63], v[180:183], v[132:135], v[60:63]
  ds_read_b128 v[144:147], v192 offset:1216
  v_cvt_pk_bf16_f32 v170, v156, v157
  v_mfma_f32_16x16x32_bf16 v[52:55], v[180:183], v[128:131], v[52:55]
  ds_read_b64_tr_b16 v[136:137], v188 offset:40960
  v_cvt_pk_bf16_f32 v171, v158, v159
  v_mfma_f32_16x16x32_bf16 v[44:47], v[180:183], v[124:127], v[44:47]
  ds_read_b64_tr_b16 v[138:139], v188 offset:41984
  v_cvt_pk_bf16_f32 v172, v160, v161
  v_mfma_f32_16x16x32_bf16 v[36:39], v[180:183], v[120:123], v[36:39]
  ds_read_b64_tr_b16 v[140:141], v189 offset:40960
  v_cvt_pk_bf16_f32 v173, v162, v163
  v_mfma_f32_16x16x32_bf16 v[28:31], v[180:183], v[116:119], v[28:31]
  ds_read_b64_tr_b16 v[142:143], v189 offset:41984
  v_cvt_pk_bf16_f32 v174, v164, v165
  v_mfma_f32_16x16x32_bf16 v[20:23], v[180:183], v[112:115], v[20:23]
  v_cvt_pk_bf16_f32 v175, v166, v167
  v_mfma_f32_16x16x32_bf16 v[12:15], v[180:183], v[108:111], v[12:15]
  v_mfma_f32_16x16x32_bf16 v[4:7], v[180:183], v[104:107], v[4:7]
  s_waitcnt lgkmcnt(4)
  v_mfma_f32_16x16x32_bf16 v[0:3], v[168:171], v[72:75], v[0:3]
  ds_read_b128 v[104:107], v185 offset:32768
  v_and_b32 v144, v144, v250
  v_mfma_f32_16x16x32_bf16 v[8:11], v[168:171], v[76:79], v[8:11]
  ds_read_b128 v[108:111], v185 offset:34816
  v_and_b32 v145, v145, v251
  v_mfma_f32_16x16x32_bf16 v[16:19], v[168:171], v[80:83], v[16:19]
  ds_read_b128 v[112:115], v185 offset:36864
  v_and_b32 v146, v146, v250
  v_mfma_f32_16x16x32_bf16 v[24:27], v[168:171], v[84:87], v[24:27]
  ds_read_b128 v[116:119], v185 offset:38912
  v_and_b32 v147, v147, v251
  v_mfma_f32_16x16x32_bf16 v[32:35], v[168:171], v[88:91], v[32:35]
  ds_read_b128 v[120:123], v185 offset:40960
  s_waitcnt lgkmcnt(5)
  v_mfma_f32_4x4x4_16b_bf16 v[152:155], v[144:145], v[136:137], 0
  v_mfma_f32_4x4x4_16b_bf16 v[156:159], v[146:147], v[138:139], 0
  v_mfma_f32_4x4x4_16b_bf16 v[160:163], v[144:145], v[140:141], 0
  v_mfma_f32_4x4x4_16b_bf16 v[164:167], v[146:147], v[142:143], 0
  v_mfma_f32_16x16x32_bf16 v[40:43], v[168:171], v[92:95], v[40:43]
  ds_read_b128 v[124:127], v185 offset:43008
  v_mfma_f32_16x16x32_bf16 v[48:51], v[168:171], v[96:99], v[48:51]
  ds_read_b128 v[128:131], v185 offset:45056
  v_cvt_pk_bf16_f32 v176, v152, v153
  v_mfma_f32_16x16x32_bf16 v[56:59], v[168:171], v[100:103], v[56:59]
  ds_read_b128 v[132:135], v185 offset:47104
  v_cvt_pk_bf16_f32 v177, v154, v155
  s_barrier
  v_mfma_f32_16x16x32_bf16 v[60:63], v[172:175], v[100:103], v[60:63]
  ds_read_b128 v[144:147], v192 offset:1280
  v_cvt_pk_bf16_f32 v178, v156, v157
  v_mfma_f32_16x16x32_bf16 v[52:55], v[172:175], v[96:99], v[52:55]
  ds_read_b64_tr_b16 v[136:137], v190 offset:0
  v_cvt_pk_bf16_f32 v179, v158, v159
  v_mfma_f32_16x16x32_bf16 v[44:47], v[172:175], v[92:95], v[44:47]
  ds_read_b64_tr_b16 v[138:139], v190 offset:1024
  v_cvt_pk_bf16_f32 v180, v160, v161
  v_mfma_f32_16x16x32_bf16 v[36:39], v[172:175], v[88:91], v[36:39]
  ds_read_b64_tr_b16 v[140:141], v191 offset:0
  v_cvt_pk_bf16_f32 v181, v162, v163
  v_mfma_f32_16x16x32_bf16 v[28:31], v[172:175], v[84:87], v[28:31]
  ds_read_b64_tr_b16 v[142:143], v191 offset:1024
  v_cvt_pk_bf16_f32 v182, v164, v165
  v_mfma_f32_16x16x32_bf16 v[20:23], v[172:175], v[80:83], v[20:23]
  v_cvt_pk_bf16_f32 v183, v166, v167
  v_mfma_f32_16x16x32_bf16 v[12:15], v[172:175], v[76:79], v[12:15]
  v_mfma_f32_16x16x32_bf16 v[4:7], v[172:175], v[72:75], v[4:7]
  s_waitcnt lgkmcnt(4)
  v_mfma_f32_16x16x32_bf16 v[0:3], v[176:179], v[104:107], v[0:3]
  ds_read_b128 v[72:75], v186 offset:0
  v_and_b32 v144, v144, v250
  v_mfma_f32_16x16x32_bf16 v[8:11], v[176:179], v[108:111], v[8:11]
  ds_read_b128 v[76:79], v186 offset:2048
  v_and_b32 v145, v145, v251
  v_mfma_f32_16x16x32_bf16 v[16:19], v[176:179], v[112:115], v[16:19]
  ds_read_b128 v[80:83], v186 offset:4096
  v_and_b32 v146, v146, v250
  v_mfma_f32_16x16x32_bf16 v[24:27], v[176:179], v[116:119], v[24:27]
  ds_read_b128 v[84:87], v186 offset:6144
  v_and_b32 v147, v147, v251
  v_mfma_f32_16x16x32_bf16 v[32:35], v[176:179], v[120:123], v[32:35]
  ds_read_b128 v[88:91], v186 offset:8192
  s_waitcnt lgkmcnt(5)
  v_mfma_f32_4x4x4_16b_bf16 v[152:155], v[144:145], v[136:137], 0
  v_mfma_f32_4x4x4_16b_bf16 v[156:159], v[146:147], v[138:139], 0
  v_mfma_f32_4x4x4_16b_bf16 v[160:163], v[144:145], v[140:141], 0
  v_mfma_f32_4x4x4_16b_bf16 v[164:167], v[146:147], v[142:143], 0
  v_mfma_f32_16x16x32_bf16 v[40:43], v[176:179], v[124:127], v[40:43]
  ds_read_b128 v[92:95], v186 offset:10240
  v_mfma_f32_16x16x32_bf16 v[48:51], v[176:179], v[128:131], v[48:51]
  ds_read_b128 v[96:99], v186 offset:12288
  v_cvt_pk_bf16_f32 v168, v152, v153
  v_mfma_f32_16x16x32_bf16 v[56:59], v[176:179], v[132:135], v[56:59]
  ds_read_b128 v[100:103], v186 offset:14336
  v_cvt_pk_bf16_f32 v169, v154, v155
  v_mfma_f32_16x16x32_bf16 v[60:63], v[180:183], v[132:135], v[60:63]
  ds_read_b128 v[144:147], v192 offset:1344
  v_cvt_pk_bf16_f32 v170, v156, v157
  v_mfma_f32_16x16x32_bf16 v[52:55], v[180:183], v[128:131], v[52:55]
  ds_read_b64_tr_b16 v[136:137], v190 offset:8192
  v_cvt_pk_bf16_f32 v171, v158, v159
  v_mfma_f32_16x16x32_bf16 v[44:47], v[180:183], v[124:127], v[44:47]
  ds_read_b64_tr_b16 v[138:139], v190 offset:9216
  v_cvt_pk_bf16_f32 v172, v160, v161
  v_mfma_f32_16x16x32_bf16 v[36:39], v[180:183], v[120:123], v[36:39]
  ds_read_b64_tr_b16 v[140:141], v191 offset:8192
  v_cvt_pk_bf16_f32 v173, v162, v163
  v_mfma_f32_16x16x32_bf16 v[28:31], v[180:183], v[116:119], v[28:31]
  ds_read_b64_tr_b16 v[142:143], v191 offset:9216
  v_cvt_pk_bf16_f32 v174, v164, v165
  v_mfma_f32_16x16x32_bf16 v[20:23], v[180:183], v[112:115], v[20:23]
  v_cvt_pk_bf16_f32 v175, v166, v167
  v_mfma_f32_16x16x32_bf16 v[12:15], v[180:183], v[108:111], v[12:15]
  v_mfma_f32_16x16x32_bf16 v[4:7], v[180:183], v[104:107], v[4:7]
  s_waitcnt lgkmcnt(4)
  v_mfma_f32_16x16x32_bf16 v[0:3], v[168:171], v[72:75], v[0:3]
  ds_read_b128 v[104:107], v187 offset:0
  v_and_b32 v144, v144, v250
  v_mfma_f32_16x16x32_bf16 v[8:11], v[168:171], v[76:79], v[8:11]
  ds_read_b128 v[108:111], v187 offset:2048
  v_and_b32 v145, v145, v251
  v_mfma_f32_16x16x32_bf16 v[16:19], v[168:171], v[80:83], v[16:19]
  ds_read_b128 v[112:115], v187 offset:4096
  v_and_b32 v146, v146, v250
  v_mfma_f32_16x16x32_bf16 v[24:27], v[168:171], v[84:87], v[24:27]
  ds_read_b128 v[116:119], v187 offset:6144
  v_and_b32 v147, v147, v251
  v_mfma_f32_16x16x32_bf16 v[32:35], v[168:171], v[88:91], v[32:35]
  ds_read_b128 v[120:123], v187 offset:8192
  s_waitcnt lgkmcnt(5)
  v_mfma_f32_4x4x4_16b_bf16 v[152:155], v[144:145], v[136:137], 0
  v_mfma_f32_4x4x4_16b_bf16 v[156:159], v[146:147], v[138:139], 0
  v_mfma_f32_4x4x4_16b_bf16 v[160:163], v[144:145], v[140:141], 0
  v_mfma_f32_4x4x4_16b_bf16 v[164:167], v[146:147], v[142:143], 0
  v_mfma_f32_16x16x32_bf16 v[40:43], v[168:171], v[92:95], v[40:43]
  ds_read_b128 v[124:127], v187 offset:10240
  v_mfma_f32_16x16x32_bf16 v[48:51], v[168:171], v[96:99], v[48:51]
  ds_read_b128 v[128:131], v187 offset:12288
  v_cvt_pk_bf16_f32 v176, v152, v153
  v_mfma_f32_16x16x32_bf16 v[56:59], v[168:171], v[100:103], v[56:59]
  ds_read_b128 v[132:135], v187 offset:14336
  v_cvt_pk_bf16_f32 v177, v154, v155
  s_barrier
  v_mfma_f32_16x16x32_bf16 v[60:63], v[172:175], v[100:103], v[60:63]
  ds_read_b128 v[144:147], v192 offset:1408
  v_cvt_pk_bf16_f32 v178, v156, v157
  v_mfma_f32_16x16x32_bf16 v[52:55], v[172:175], v[96:99], v[52:55]
  ds_read_b64_tr_b16 v[136:137], v190 offset:32768
  v_cvt_pk_bf16_f32 v179, v158, v159
  v_mfma_f32_16x16x32_bf16 v[44:47], v[172:175], v[92:95], v[44:47]
  ds_read_b64_tr_b16 v[138:139], v190 offset:33792
  v_cvt_pk_bf16_f32 v180, v160, v161
  v_mfma_f32_16x16x32_bf16 v[36:39], v[172:175], v[88:91], v[36:39]
  ds_read_b64_tr_b16 v[140:141], v191 offset:32768
  v_cvt_pk_bf16_f32 v181, v162, v163
  v_mfma_f32_16x16x32_bf16 v[28:31], v[172:175], v[84:87], v[28:31]
  ds_read_b64_tr_b16 v[142:143], v191 offset:33792
  v_cvt_pk_bf16_f32 v182, v164, v165
  v_mfma_f32_16x16x32_bf16 v[20:23], v[172:175], v[80:83], v[20:23]
  v_cvt_pk_bf16_f32 v183, v166, v167
  v_mfma_f32_16x16x32_bf16 v[12:15], v[172:175], v[76:79], v[12:15]
  v_mfma_f32_16x16x32_bf16 v[4:7], v[172:175], v[72:75], v[4:7]
  s_waitcnt lgkmcnt(4)
  v_mfma_f32_16x16x32_bf16 v[0:3], v[176:179], v[104:107], v[0:3]
  ds_read_b128 v[72:75], v186 offset:32768
  v_and_b32 v144, v144, v250
  v_mfma_f32_16x16x32_bf16 v[8:11], v[176:179], v[108:111], v[8:11]
  ds_read_b128 v[76:79], v186 offset:34816
  v_and_b32 v145, v145, v251
  v_mfma_f32_16x16x32_bf16 v[16:19], v[176:179], v[112:115], v[16:19]
  ds_read_b128 v[80:83], v186 offset:36864
  v_and_b32 v146, v146, v250
  v_mfma_f32_16x16x32_bf16 v[24:27], v[176:179], v[116:119], v[24:27]
  ds_read_b128 v[84:87], v186 offset:38912
  v_and_b32 v147, v147, v251
  v_mfma_f32_16x16x32_bf16 v[32:35], v[176:179], v[120:123], v[32:35]
  ds_read_b128 v[88:91], v186 offset:40960
  s_waitcnt lgkmcnt(5)
  v_mfma_f32_4x4x4_16b_bf16 v[152:155], v[144:145], v[136:137], 0
  v_mfma_f32_4x4x4_16b_bf16 v[156:159], v[146:147], v[138:139], 0
  v_mfma_f32_4x4x4_16b_bf16 v[160:163], v[144:145], v[140:141], 0
  v_mfma_f32_4x4x4_16b_bf16 v[164:167], v[146:147], v[142:143], 0
  v_mfma_f32_16x16x32_bf16 v[40:43], v[176:179], v[124:127], v[40:43]
  ds_read_b128 v[92:95], v186 offset:43008
  v_mfma_f32_16x16x32_bf16 v[48:51], v[176:179], v[128:131], v[48:51]
  ds_read_b128 v[96:99], v186 offset:45056
  v_cvt_pk_bf16_f32 v168, v152, v153
  v_mfma_f32_16x16x32_bf16 v[56:59], v[176:179], v[132:135], v[56:59]
  ds_read_b128 v[100:103], v186 offset:47104
  v_cvt_pk_bf16_f32 v169, v154, v155
  v_mfma_f32_16x16x32_bf16 v[60:63], v[180:183], v[132:135], v[60:63]
  ds_read_b128 v[144:147], v192 offset:1472
  v_cvt_pk_bf16_f32 v170, v156, v157
  v_mfma_f32_16x16x32_bf16 v[52:55], v[180:183], v[128:131], v[52:55]
  ds_read_b64_tr_b16 v[136:137], v190 offset:40960
  v_cvt_pk_bf16_f32 v171, v158, v159
  v_mfma_f32_16x16x32_bf16 v[44:47], v[180:183], v[124:127], v[44:47]
  ds_read_b64_tr_b16 v[138:139], v190 offset:41984
  v_cvt_pk_bf16_f32 v172, v160, v161
  v_mfma_f32_16x16x32_bf16 v[36:39], v[180:183], v[120:123], v[36:39]
  ds_read_b64_tr_b16 v[140:141], v191 offset:40960
  v_cvt_pk_bf16_f32 v173, v162, v163
  v_mfma_f32_16x16x32_bf16 v[28:31], v[180:183], v[116:119], v[28:31]
  ds_read_b64_tr_b16 v[142:143], v191 offset:41984
  v_cvt_pk_bf16_f32 v174, v164, v165
  v_mfma_f32_16x16x32_bf16 v[20:23], v[180:183], v[112:115], v[20:23]
  v_cvt_pk_bf16_f32 v175, v166, v167
  v_mfma_f32_16x16x32_bf16 v[12:15], v[180:183], v[108:111], v[12:15]
  v_mfma_f32_16x16x32_bf16 v[4:7], v[180:183], v[104:107], v[4:7]
  s_waitcnt lgkmcnt(4)
  v_mfma_f32_16x16x32_bf16 v[0:3], v[168:171], v[72:75], v[0:3]
  ds_read_b128 v[104:107], v187 offset:32768
  v_and_b32 v144, v144, v250
  v_mfma_f32_16x16x32_bf16 v[8:11], v[168:171], v[76:79], v[8:11]
  ds_read_b128 v[108:111], v187 offset:34816
  v_and_b32 v145, v145, v251
  v_mfma_f32_16x16x32_bf16 v[16:19], v[168:171], v[80:83], v[16:19]
  ds_read_b128 v[112:115], v187 offset:36864
  v_and_b32 v146, v146, v250
  v_mfma_f32_16x16x32_bf16 v[24:27], v[168:171], v[84:87], v[24:27]
  ds_read_b128 v[116:119], v187 offset:38912
  v_and_b32 v147, v147, v251
  v_mfma_f32_16x16x32_bf16 v[32:35], v[168:171], v[88:91], v[32:35]
  ds_read_b128 v[120:123], v187 offset:40960
  s_waitcnt lgkmcnt(5)
  v_mfma_f32_4x4x4_16b_bf16 v[152:155], v[144:145], v[136:137], 0
  v_mfma_f32_4x4x4_16b_bf16 v[156:159], v[146:147], v[138:139], 0
  v_mfma_f32_4x4x4_16b_bf16 v[160:163], v[144:145], v[140:141], 0
  v_mfma_f32_4x4x4_16b_bf16 v[164:167], v[146:147], v[142:143], 0
  v_mfma_f32_16x16x32_bf16 v[40:43], v[168:171], v[92:95], v[40:43]
  ds_read_b128 v[124:127], v187 offset:43008
  v_mfma_f32_16x16x32_bf16 v[48:51], v[168:171], v[96:99], v[48:51]
  ds_read_b128 v[128:131], v187 offset:45056
  v_cvt_pk_bf16_f32 v176, v152, v153
  v_mfma_f32_16x16x32_bf16 v[56:59], v[168:171], v[100:103], v[56:59]
  ds_read_b128 v[132:135], v187 offset:47104
  v_cvt_pk_bf16_f32 v177, v154, v155
  s_barrier
  v_mfma_f32_16x16x32_bf16 v[60:63], v[172:175], v[100:103], v[60:63]
  ds_read_b128 v[144:147], v192 offset:1536
  v_cvt_pk_bf16_f32 v178, v156, v157
  v_mfma_f32_16x16x32_bf16 v[52:55], v[172:175], v[96:99], v[52:55]
  ds_read_b64_tr_b16 v[136:137], v188 offset:0
  v_cvt_pk_bf16_f32 v179, v158, v159
  v_mfma_f32_16x16x32_bf16 v[44:47], v[172:175], v[92:95], v[44:47]
  ds_read_b64_tr_b16 v[138:139], v188 offset:1024
  v_cvt_pk_bf16_f32 v180, v160, v161
  v_mfma_f32_16x16x32_bf16 v[36:39], v[172:175], v[88:91], v[36:39]
  ds_read_b64_tr_b16 v[140:141], v189 offset:0
  v_cvt_pk_bf16_f32 v181, v162, v163
  v_mfma_f32_16x16x32_bf16 v[28:31], v[172:175], v[84:87], v[28:31]
  ds_read_b64_tr_b16 v[142:143], v189 offset:1024
  v_cvt_pk_bf16_f32 v182, v164, v165
  v_mfma_f32_16x16x32_bf16 v[20:23], v[172:175], v[80:83], v[20:23]
  v_cvt_pk_bf16_f32 v183, v166, v167
  v_mfma_f32_16x16x32_bf16 v[12:15], v[172:175], v[76:79], v[12:15]
  v_mfma_f32_16x16x32_bf16 v[4:7], v[172:175], v[72:75], v[4:7]
  s_waitcnt lgkmcnt(4)
  v_mfma_f32_16x16x32_bf16 v[0:3], v[176:179], v[104:107], v[0:3]
  ds_read_b128 v[72:75], v184 offset:0
  v_and_b32 v144, v144, v250
  v_mfma_f32_16x16x32_bf16 v[8:11], v[176:179], v[108:111], v[8:11]
  ds_read_b128 v[76:79], v184 offset:2048
  v_and_b32 v145, v145, v251
  v_mfma_f32_16x16x32_bf16 v[16:19], v[176:179], v[112:115], v[16:19]
  ds_read_b128 v[80:83], v184 offset:4096
  v_and_b32 v146, v146, v250
  v_mfma_f32_16x16x32_bf16 v[24:27], v[176:179], v[116:119], v[24:27]
  ds_read_b128 v[84:87], v184 offset:6144
  v_and_b32 v147, v147, v251
  v_mfma_f32_16x16x32_bf16 v[32:35], v[176:179], v[120:123], v[32:35]
  ds_read_b128 v[88:91], v184 offset:8192
  s_waitcnt lgkmcnt(5)
  v_mfma_f32_4x4x4_16b_bf16 v[152:155], v[144:145], v[136:137], 0
  v_mfma_f32_4x4x4_16b_bf16 v[156:159], v[146:147], v[138:139], 0
  v_mfma_f32_4x4x4_16b_bf16 v[160:163], v[144:145], v[140:141], 0
  v_mfma_f32_4x4x4_16b_bf16 v[164:167], v[146:147], v[142:143], 0
  v_mfma_f32_16x16x32_bf16 v[40:43], v[176:179], v[124:127], v[40:43]
  ds_read_b128 v[92:95], v184 offset:10240
  v_mfma_f32_16x16x32_bf16 v[48:51], v[176:179], v[128:131], v[48:51]
  ds_read_b128 v[96:99], v184 offset:12288
  v_cvt_pk_bf16_f32 v168, v152, v153
  v_mfma_f32_16x16x32_bf16 v[56:59], v[176:179], v[132:135], v[56:59]
  ds_read_b128 v[100:103], v184 offset:14336
  v_cvt_pk_bf16_f32 v169, v154, v155
  v_mfma_f32_16x16x32_bf16 v[60:63], v[180:183], v[132:135], v[60:63]
  ds_read_b128 v[144:147], v192 offset:1600
  v_cvt_pk_bf16_f32 v170, v156, v157
  v_mfma_f32_16x16x32_bf16 v[52:55], v[180:183], v[128:131], v[52:55]
  ds_read_b64_tr_b16 v[136:137], v188 offset:8192
  v_cvt_pk_bf16_f32 v171, v158, v159
  v_mfma_f32_16x16x32_bf16 v[44:47], v[180:183], v[124:127], v[44:47]
  ds_read_b64_tr_b16 v[138:139], v188 offset:9216
  v_cvt_pk_bf16_f32 v172, v160, v161
  v_mfma_f32_16x16x32_bf16 v[36:39], v[180:183], v[120:123], v[36:39]
  ds_read_b64_tr_b16 v[140:141], v189 offset:8192
  v_cvt_pk_bf16_f32 v173, v162, v163
  v_mfma_f32_16x16x32_bf16 v[28:31], v[180:183], v[116:119], v[28:31]
  ds_read_b64_tr_b16 v[142:143], v189 offset:9216
  v_cvt_pk_bf16_f32 v174, v164, v165
  v_mfma_f32_16x16x32_bf16 v[20:23], v[180:183], v[112:115], v[20:23]
  v_cvt_pk_bf16_f32 v175, v166, v167
  v_mfma_f32_16x16x32_bf16 v[12:15], v[180:183], v[108:111], v[12:15]
  v_mfma_f32_16x16x32_bf16 v[4:7], v[180:183], v[104:107], v[4:7]
  s_waitcnt lgkmcnt(4)
  v_mfma_f32_16x16x32_bf16 v[0:3], v[168:171], v[72:75], v[0:3]
  ds_read_b128 v[104:107], v185 offset:0
  v_and_b32 v144, v144, v250
  v_mfma_f32_16x16x32_bf16 v[8:11], v[168:171], v[76:79], v[8:11]
  ds_read_b128 v[108:111], v185 offset:2048
  v_and_b32 v145, v145, v251
  v_mfma_f32_16x16x32_bf16 v[16:19], v[168:171], v[80:83], v[16:19]
  ds_read_b128 v[112:115], v185 offset:4096
  v_and_b32 v146, v146, v250
  v_mfma_f32_16x16x32_bf16 v[24:27], v[168:171], v[84:87], v[24:27]
  ds_read_b128 v[116:119], v185 offset:6144
  v_and_b32 v147, v147, v251
  v_mfma_f32_16x16x32_bf16 v[32:35], v[168:171], v[88:91], v[32:35]
  ds_read_b128 v[120:123], v185 offset:8192
  s_waitcnt lgkmcnt(5)
  v_mfma_f32_4x4x4_16b_bf16 v[152:155], v[144:145], v[136:137], 0
  v_mfma_f32_4x4x4_16b_bf16 v[156:159], v[146:147], v[138:139], 0
  v_mfma_f32_4x4x4_16b_bf16 v[160:163], v[144:145], v[140:141], 0
  v_mfma_f32_4x4x4_16b_bf16 v[164:167], v[146:147], v[142:143], 0
  v_mfma_f32_16x16x32_bf16 v[40:43], v[168:171], v[92:95], v[40:43]
  ds_read_b128 v[124:127], v185 offset:10240
  v_mfma_f32_16x16x32_bf16 v[48:51], v[168:171], v[96:99], v[48:51]
  ds_read_b128 v[128:131], v185 offset:12288
  v_cvt_pk_bf16_f32 v176, v152, v153
  v_mfma_f32_16x16x32_bf16 v[56:59], v[168:171], v[100:103], v[56:59]
  ds_read_b128 v[132:135], v185 offset:14336
  v_cvt_pk_bf16_f32 v177, v154, v155
  s_barrier
  v_mfma_f32_16x16x32_bf16 v[60:63], v[172:175], v[100:103], v[60:63]
  ds_read_b128 v[144:147], v192 offset:1664
  v_cvt_pk_bf16_f32 v178, v156, v157
  v_mfma_f32_16x16x32_bf16 v[52:55], v[172:175], v[96:99], v[52:55]
  ds_read_b64_tr_b16 v[136:137], v188 offset:32768
  v_cvt_pk_bf16_f32 v179, v158, v159
  v_mfma_f32_16x16x32_bf16 v[44:47], v[172:175], v[92:95], v[44:47]
  ds_read_b64_tr_b16 v[138:139], v188 offset:33792
  v_cvt_pk_bf16_f32 v180, v160, v161
  v_mfma_f32_16x16x32_bf16 v[36:39], v[172:175], v[88:91], v[36:39]
  ds_read_b64_tr_b16 v[140:141], v189 offset:32768
  v_cvt_pk_bf16_f32 v181, v162, v163
  v_mfma_f32_16x16x32_bf16 v[28:31], v[172:175], v[84:87], v[28:31]
  ds_read_b64_tr_b16 v[142:143], v189 offset:33792
  v_cvt_pk_bf16_f32 v182, v164, v165
  v_mfma_f32_16x16x32_bf16 v[20:23], v[172:175], v[80:83], v[20:23]
  v_cvt_pk_bf16_f32 v183, v166, v167
  v_mfma_f32_16x16x32_bf16 v[12:15], v[172:175], v[76:79], v[12:15]
  v_mfma_f32_16x16x32_bf16 v[4:7], v[172:175], v[72:75], v[4:7]
  s_waitcnt lgkmcnt(4)
  v_mfma_f32_16x16x32_bf16 v[0:3], v[176:179], v[104:107], v[0:3]
  ds_read_b128 v[72:75], v184 offset:32768
  v_and_b32 v144, v144, v250
  v_mfma_f32_16x16x32_bf16 v[8:11], v[176:179], v[108:111], v[8:11]
  ds_read_b128 v[76:79], v184 offset:34816
  v_and_b32 v145, v145, v251
  v_mfma_f32_16x16x32_bf16 v[16:19], v[176:179], v[112:115], v[16:19]
  ds_read_b128 v[80:83], v184 offset:36864
  v_and_b32 v146, v146, v250
  v_mfma_f32_16x16x32_bf16 v[24:27], v[176:179], v[116:119], v[24:27]
  ds_read_b128 v[84:87], v184 offset:38912
  v_and_b32 v147, v147, v251
  v_mfma_f32_16x16x32_bf16 v[32:35], v[176:179], v[120:123], v[32:35]
  ds_read_b128 v[88:91], v184 offset:40960
  s_waitcnt lgkmcnt(5)
  v_mfma_f32_4x4x4_16b_bf16 v[152:155], v[144:145], v[136:137], 0
  v_mfma_f32_4x4x4_16b_bf16 v[156:159], v[146:147], v[138:139], 0
  v_mfma_f32_4x4x4_16b_bf16 v[160:163], v[144:145], v[140:141], 0
  v_mfma_f32_4x4x4_16b_bf16 v[164:167], v[146:147], v[142:143], 0
  v_mfma_f32_16x16x32_bf16 v[40:43], v[176:179], v[124:127], v[40:43]
  ds_read_b128 v[92:95], v184 offset:43008
  v_mfma_f32_16x16x32_bf16 v[48:51], v[176:179], v[128:131], v[48:51]
  ds_read_b128 v[96:99], v184 offset:45056
  v_cvt_pk_bf16_f32 v168, v152, v153
  v_mfma_f32_16x16x32_bf16 v[56:59], v[176:179], v[132:135], v[56:59]
  ds_read_b128 v[100:103], v184 offset:47104
  v_cvt_pk_bf16_f32 v169, v154, v155
  v_mfma_f32_16x16x32_bf16 v[60:63], v[180:183], v[132:135], v[60:63]
  ds_read_b128 v[144:147], v192 offset:1728
  v_cvt_pk_bf16_f32 v170, v156, v157
  v_mfma_f32_16x16x32_bf16 v[52:55], v[180:183], v[128:131], v[52:55]
  ds_read_b64_tr_b16 v[136:137], v188 offset:40960
  v_cvt_pk_bf16_f32 v171, v158, v159
  v_mfma_f32_16x16x32_bf16 v[44:47], v[180:183], v[124:127], v[44:47]
  ds_read_b64_tr_b16 v[138:139], v188 offset:41984
  v_cvt_pk_bf16_f32 v172, v160, v161
  v_mfma_f32_16x16x32_bf16 v[36:39], v[180:183], v[120:123], v[36:39]
  ds_read_b64_tr_b16 v[140:141], v189 offset:40960
  v_cvt_pk_bf16_f32 v173, v162, v163
  v_mfma_f32_16x16x32_bf16 v[28:31], v[180:183], v[116:119], v[28:31]
  ds_read_b64_tr_b16 v[142:143], v189 offset:41984
  v_cvt_pk_bf16_f32 v174, v164, v165
  v_mfma_f32_16x16x32_bf16 v[20:23], v[180:183], v[112:115], v[20:23]
  v_cvt_pk_bf16_f32 v175, v166, v167
  v_mfma_f32_16x16x32_bf16 v[12:15], v[180:183], v[108:111], v[12:15]
  v_mfma_f32_16x16x32_bf16 v[4:7], v[180:183], v[104:107], v[4:7]
  s_waitcnt lgkmcnt(4)
  v_mfma_f32_16x16x32_bf16 v[0:3], v[168:171], v[72:75], v[0:3]
  ds_read_b128 v[104:107], v185 offset:32768
  v_and_b32 v144, v144, v250
  v_mfma_f32_16x16x32_bf16 v[8:11], v[168:171], v[76:79], v[8:11]
  ds_read_b128 v[108:111], v185 offset:34816
  v_and_b32 v145, v145, v251
  v_mfma_f32_16x16x32_bf16 v[16:19], v[168:171], v[80:83], v[16:19]
  ds_read_b128 v[112:115], v185 offset:36864
  v_and_b32 v146, v146, v250
  v_mfma_f32_16x16x32_bf16 v[24:27], v[168:171], v[84:87], v[24:27]
  ds_read_b128 v[116:119], v185 offset:38912
  v_and_b32 v147, v147, v251
  v_mfma_f32_16x16x32_bf16 v[32:35], v[168:171], v[88:91], v[32:35]
  ds_read_b128 v[120:123], v185 offset:40960
  s_waitcnt lgkmcnt(5)
  v_mfma_f32_4x4x4_16b_bf16 v[152:155], v[144:145], v[136:137], 0
  v_mfma_f32_4x4x4_16b_bf16 v[156:159], v[146:147], v[138:139], 0
  v_mfma_f32_4x4x4_16b_bf16 v[160:163], v[144:145], v[140:141], 0
  v_mfma_f32_4x4x4_16b_bf16 v[164:167], v[146:147], v[142:143], 0
  v_mfma_f32_16x16x32_bf16 v[40:43], v[168:171], v[92:95], v[40:43]
  ds_read_b128 v[124:127], v185 offset:43008
  v_mfma_f32_16x16x32_bf16 v[48:51], v[168:171], v[96:99], v[48:51]
  ds_read_b128 v[128:131], v185 offset:45056
  v_cvt_pk_bf16_f32 v176, v152, v153
  v_mfma_f32_16x16x32_bf16 v[56:59], v[168:171], v[100:103], v[56:59]
  ds_read_b128 v[132:135], v185 offset:47104
  v_cvt_pk_bf16_f32 v177, v154, v155
  s_barrier
  v_mfma_f32_16x16x32_bf16 v[60:63], v[172:175], v[100:103], v[60:63]
  ds_read_b128 v[144:147], v192 offset:1792
  v_cvt_pk_bf16_f32 v178, v156, v157
  v_mfma_f32_16x16x32_bf16 v[52:55], v[172:175], v[96:99], v[52:55]
  ds_read_b64_tr_b16 v[136:137], v190 offset:0
  v_cvt_pk_bf16_f32 v179, v158, v159
  v_mfma_f32_16x16x32_bf16 v[44:47], v[172:175], v[92:95], v[44:47]
  ds_read_b64_tr_b16 v[138:139], v190 offset:1024
  v_cvt_pk_bf16_f32 v180, v160, v161
  v_mfma_f32_16x16x32_bf16 v[36:39], v[172:175], v[88:91], v[36:39]
  ds_read_b64_tr_b16 v[140:141], v191 offset:0
  v_cvt_pk_bf16_f32 v181, v162, v163
  v_mfma_f32_16x16x32_bf16 v[28:31], v[172:175], v[84:87], v[28:31]
  ds_read_b64_tr_b16 v[142:143], v191 offset:1024
  v_cvt_pk_bf16_f32 v182, v164, v165
  v_mfma_f32_16x16x32_bf16 v[20:23], v[172:175], v[80:83], v[20:23]
  v_cvt_pk_bf16_f32 v183, v166, v167
  v_mfma_f32_16x16x32_bf16 v[12:15], v[172:175], v[76:79], v[12:15]
  v_mfma_f32_16x16x32_bf16 v[4:7], v[172:175], v[72:75], v[4:7]
  s_waitcnt lgkmcnt(4)
  v_mfma_f32_16x16x32_bf16 v[0:3], v[176:179], v[104:107], v[0:3]
  ds_read_b128 v[72:75], v186 offset:0
  v_and_b32 v144, v144, v250
  v_mfma_f32_16x16x32_bf16 v[8:11], v[176:179], v[108:111], v[8:11]
  ds_read_b128 v[76:79], v186 offset:2048
  v_and_b32 v145, v145, v251
  v_mfma_f32_16x16x32_bf16 v[16:19], v[176:179], v[112:115], v[16:19]
  ds_read_b128 v[80:83], v186 offset:4096
  v_and_b32 v146, v146, v250
  v_mfma_f32_16x16x32_bf16 v[24:27], v[176:179], v[116:119], v[24:27]
  ds_read_b128 v[84:87], v186 offset:6144
  v_and_b32 v147, v147, v251
  v_mfma_f32_16x16x32_bf16 v[32:35], v[176:179], v[120:123], v[32:35]
  ds_read_b128 v[88:91], v186 offset:8192
  s_waitcnt lgkmcnt(5)
  v_mfma_f32_4x4x4_16b_bf16 v[152:155], v[144:145], v[136:137], 0
  v_mfma_f32_4x4x4_16b_bf16 v[156:159], v[146:147], v[138:139], 0
  v_mfma_f32_4x4x4_16b_bf16 v[160:163], v[144:145], v[140:141], 0
  v_mfma_f32_4x4x4_16b_bf16 v[164:167], v[146:147], v[142:143], 0
  v_mfma_f32_16x16x32_bf16 v[40:43], v[176:179], v[124:127], v[40:43]
  ds_read_b128 v[92:95], v186 offset:10240
  v_mfma_f32_16x16x32_bf16 v[48:51], v[176:179], v[128:131], v[48:51]
  ds_read_b128 v[96:99], v186 offset:12288
  v_cvt_pk_bf16_f32 v168, v152, v153
  v_mfma_f32_16x16x32_bf16 v[56:59], v[176:179], v[132:135], v[56:59]
  ds_read_b128 v[100:103], v186 offset:14336
  v_cvt_pk_bf16_f32 v169, v154, v155
  v_mfma_f32_16x16x32_bf16 v[60:63], v[180:183], v[132:135], v[60:63]
  ds_read_b128 v[144:147], v192 offset:1856
  v_cvt_pk_bf16_f32 v170, v156, v157
  v_mfma_f32_16x16x32_bf16 v[52:55], v[180:183], v[128:131], v[52:55]
  ds_read_b64_tr_b16 v[136:137], v190 offset:8192
  v_cvt_pk_bf16_f32 v171, v158, v159
  v_mfma_f32_16x16x32_bf16 v[44:47], v[180:183], v[124:127], v[44:47]
  ds_read_b64_tr_b16 v[138:139], v190 offset:9216
  v_cvt_pk_bf16_f32 v172, v160, v161
  v_mfma_f32_16x16x32_bf16 v[36:39], v[180:183], v[120:123], v[36:39]
  ds_read_b64_tr_b16 v[140:141], v191 offset:8192
  v_cvt_pk_bf16_f32 v173, v162, v163
  v_mfma_f32_16x16x32_bf16 v[28:31], v[180:183], v[116:119], v[28:31]
  ds_read_b64_tr_b16 v[142:143], v191 offset:9216
  v_cvt_pk_bf16_f32 v174, v164, v165
  v_mfma_f32_16x16x32_bf16 v[20:23], v[180:183], v[112:115], v[20:23]
  v_cvt_pk_bf16_f32 v175, v166, v167
  v_mfma_f32_16x16x32_bf16 v[12:15], v[180:183], v[108:111], v[12:15]
  v_mfma_f32_16x16x32_bf16 v[4:7], v[180:183], v[104:107], v[4:7]
  s_waitcnt lgkmcnt(4)
  v_mfma_f32_16x16x32_bf16 v[0:3], v[168:171], v[72:75], v[0:3]
  ds_read_b128 v[104:107], v187 offset:0
  v_and_b32 v144, v144, v250
  v_mfma_f32_16x16x32_bf16 v[8:11], v[168:171], v[76:79], v[8:11]
  ds_read_b128 v[108:111], v187 offset:2048
  v_and_b32 v145, v145, v251
  v_mfma_f32_16x16x32_bf16 v[16:19], v[168:171], v[80:83], v[16:19]
  ds_read_b128 v[112:115], v187 offset:4096
  v_and_b32 v146, v146, v250
  v_mfma_f32_16x16x32_bf16 v[24:27], v[168:171], v[84:87], v[24:27]
  ds_read_b128 v[116:119], v187 offset:6144
  v_and_b32 v147, v147, v251
  v_mfma_f32_16x16x32_bf16 v[32:35], v[168:171], v[88:91], v[32:35]
  ds_read_b128 v[120:123], v187 offset:8192
  s_waitcnt lgkmcnt(5)
  v_mfma_f32_4x4x4_16b_bf16 v[152:155], v[144:145], v[136:137], 0
  v_mfma_f32_4x4x4_16b_bf16 v[156:159], v[146:147], v[138:139], 0
  v_mfma_f32_4x4x4_16b_bf16 v[160:163], v[144:145], v[140:141], 0
  v_mfma_f32_4x4x4_16b_bf16 v[164:167], v[146:147], v[142:143], 0
  v_mfma_f32_16x16x32_bf16 v[40:43], v[168:171], v[92:95], v[40:43]
  ds_read_b128 v[124:127], v187 offset:10240
  v_mfma_f32_16x16x32_bf16 v[48:51], v[168:171], v[96:99], v[48:51]
  ds_read_b128 v[128:131], v187 offset:12288
  v_cvt_pk_bf16_f32 v176, v152, v153
  v_mfma_f32_16x16x32_bf16 v[56:59], v[168:171], v[100:103], v[56:59]
  ds_read_b128 v[132:135], v187 offset:14336
  v_cvt_pk_bf16_f32 v177, v154, v155
  s_barrier
  v_mfma_f32_16x16x32_bf16 v[60:63], v[172:175], v[100:103], v[60:63]
  ds_read_b128 v[144:147], v192 offset:1920
  v_cvt_pk_bf16_f32 v178, v156, v157
  v_mfma_f32_16x16x32_bf16 v[52:55], v[172:175], v[96:99], v[52:55]
  ds_read_b64_tr_b16 v[136:137], v190 offset:32768
  v_cvt_pk_bf16_f32 v179, v158, v159
  v_mfma_f32_16x16x32_bf16 v[44:47], v[172:175], v[92:95], v[44:47]
  ds_read_b64_tr_b16 v[138:139], v190 offset:33792
  v_cvt_pk_bf16_f32 v180, v160, v161
  v_mfma_f32_16x16x32_bf16 v[36:39], v[172:175], v[88:91], v[36:39]
  ds_read_b64_tr_b16 v[140:141], v191 offset:32768
  v_cvt_pk_bf16_f32 v181, v162, v163
  v_mfma_f32_16x16x32_bf16 v[28:31], v[172:175], v[84:87], v[28:31]
  ds_read_b64_tr_b16 v[142:143], v191 offset:33792
  v_cvt_pk_bf16_f32 v182, v164, v165
  v_mfma_f32_16x16x32_bf16 v[20:23], v[172:175], v[80:83], v[20:23]
  v_cvt_pk_bf16_f32 v183, v166, v167
  v_mfma_f32_16x16x32_bf16 v[12:15], v[172:175], v[76:79], v[12:15]
  v_mfma_f32_16x16x32_bf16 v[4:7], v[172:175], v[72:75], v[4:7]
  s_waitcnt lgkmcnt(4)
  v_mfma_f32_16x16x32_bf16 v[0:3], v[176:179], v[104:107], v[0:3]
  ds_read_b128 v[72:75], v186 offset:32768
  v_and_b32 v144, v144, v250
  v_mfma_f32_16x16x32_bf16 v[8:11], v[176:179], v[108:111], v[8:11]
  ds_read_b128 v[76:79], v186 offset:34816
  v_and_b32 v145, v145, v251
  v_mfma_f32_16x16x32_bf16 v[16:19], v[176:179], v[112:115], v[16:19]
  ds_read_b128 v[80:83], v186 offset:36864
  v_and_b32 v146, v146, v250
  v_mfma_f32_16x16x32_bf16 v[24:27], v[176:179], v[116:119], v[24:27]
  ds_read_b128 v[84:87], v186 offset:38912
  v_and_b32 v147, v147, v251
  v_mfma_f32_16x16x32_bf16 v[32:35], v[176:179], v[120:123], v[32:35]
  ds_read_b128 v[88:91], v186 offset:40960
  s_waitcnt lgkmcnt(5)
  v_mfma_f32_4x4x4_16b_bf16 v[152:155], v[144:145], v[136:137], 0
  v_mfma_f32_4x4x4_16b_bf16 v[156:159], v[146:147], v[138:139], 0
  v_mfma_f32_4x4x4_16b_bf16 v[160:163], v[144:145], v[140:141], 0
  v_mfma_f32_4x4x4_16b_bf16 v[164:167], v[146:147], v[142:143], 0
  v_mfma_f32_16x16x32_bf16 v[40:43], v[176:179], v[124:127], v[40:43]
  ds_read_b128 v[92:95], v186 offset:43008
  v_mfma_f32_16x16x32_bf16 v[48:51], v[176:179], v[128:131], v[48:51]
  ds_read_b128 v[96:99], v186 offset:45056
  v_cvt_pk_bf16_f32 v168, v152, v153
  v_mfma_f32_16x16x32_bf16 v[56:59], v[176:179], v[132:135], v[56:59]
  ds_read_b128 v[100:103], v186 offset:47104
  v_cvt_pk_bf16_f32 v169, v154, v155
  v_mfma_f32_16x16x32_bf16 v[60:63], v[180:183], v[132:135], v[60:63]
  ds_read_b128 v[144:147], v192 offset:1984
  v_cvt_pk_bf16_f32 v170, v156, v157
  v_mfma_f32_16x16x32_bf16 v[52:55], v[180:183], v[128:131], v[52:55]
  ds_read_b64_tr_b16 v[136:137], v190 offset:40960
  v_cvt_pk_bf16_f32 v171, v158, v159
  v_mfma_f32_16x16x32_bf16 v[44:47], v[180:183], v[124:127], v[44:47]
  ds_read_b64_tr_b16 v[138:139], v190 offset:41984
  v_cvt_pk_bf16_f32 v172, v160, v161
  v_mfma_f32_16x16x32_bf16 v[36:39], v[180:183], v[120:123], v[36:39]
  ds_read_b64_tr_b16 v[140:141], v191 offset:40960
  v_cvt_pk_bf16_f32 v173, v162, v163
  v_mfma_f32_16x16x32_bf16 v[28:31], v[180:183], v[116:119], v[28:31]
  ds_read_b64_tr_b16 v[142:143], v191 offset:41984
  v_cvt_pk_bf16_f32 v174, v164, v165
  v_mfma_f32_16x16x32_bf16 v[20:23], v[180:183], v[112:115], v[20:23]
  v_cvt_pk_bf16_f32 v175, v166, v167
  v_mfma_f32_16x16x32_bf16 v[12:15], v[180:183], v[108:111], v[12:15]
  v_mfma_f32_16x16x32_bf16 v[4:7], v[180:183], v[104:107], v[4:7]
  s_waitcnt lgkmcnt(4)
  v_mfma_f32_16x16x32_bf16 v[0:3], v[168:171], v[72:75], v[0:3]
  ds_read_b128 v[104:107], v187 offset:32768
  v_and_b32 v144, v144, v250
  v_mfma_f32_16x16x32_bf16 v[8:11], v[168:171], v[76:79], v[8:11]
  ds_read_b128 v[108:111], v187 offset:34816
  v_and_b32 v145, v145, v251
  v_mfma_f32_16x16x32_bf16 v[16:19], v[168:171], v[80:83], v[16:19]
  ds_read_b128 v[112:115], v187 offset:36864
  v_and_b32 v146, v146, v250
  v_mfma_f32_16x16x32_bf16 v[24:27], v[168:171], v[84:87], v[24:27]
  ds_read_b128 v[116:119], v187 offset:38912
  v_and_b32 v147, v147, v251
  v_mfma_f32_16x16x32_bf16 v[32:35], v[168:171], v[88:91], v[32:35]
  ds_read_b128 v[120:123], v187 offset:40960
  s_waitcnt lgkmcnt(5)
  v_mfma_f32_4x4x4_16b_bf16 v[152:155], v[144:145], v[136:137], 0
  v_mfma_f32_4x4x4_16b_bf16 v[156:159], v[146:147], v[138:139], 0
  v_mfma_f32_4x4x4_16b_bf16 v[160:163], v[144:145], v[140:141], 0
  v_mfma_f32_4x4x4_16b_bf16 v[164:167], v[146:147], v[142:143], 0
  v_mfma_f32_16x16x32_bf16 v[40:43], v[168:171], v[92:95], v[40:43]
  ds_read_b128 v[124:127], v187 offset:43008
  v_mfma_f32_16x16x32_bf16 v[48:51], v[168:171], v[96:99], v[48:51]
  ds_read_b128 v[128:131], v187 offset:45056
  v_cvt_pk_bf16_f32 v176, v152, v153
  v_mfma_f32_16x16x32_bf16 v[56:59], v[168:171], v[100:103], v[56:59]
  ds_read_b128 v[132:135], v187 offset:47104
  v_cvt_pk_bf16_f32 v177, v154, v155
  s_barrier
  v_mfma_f32_16x16x32_bf16 v[60:63], v[172:175], v[100:103], v[60:63]
  v_cvt_pk_bf16_f32 v178, v156, v157
  ds_read_b64 v[224:225], v248 offset:0
  ds_read_b128 v[208:211], v253 offset:0
  v_mfma_f32_16x16x32_bf16 v[52:55], v[172:175], v[96:99], v[52:55]
  v_cvt_pk_bf16_f32 v179, v158, v159
  ds_read_b64 v[226:227], v248 offset:128
  ds_read_b128 v[216:219], v253 offset:512
  v_mfma_f32_16x16x32_bf16 v[44:47], v[172:175], v[92:95], v[44:47]
  v_cvt_pk_bf16_f32 v180, v160, v161
  ds_read_b64 v[228:229], v248 offset:256
  ds_read_b128 v[212:215], v253 offset:64
  v_mfma_f32_16x16x32_bf16 v[36:39], v[172:175], v[88:91], v[36:39]
  v_cvt_pk_bf16_f32 v181, v162, v163
  ds_read_b64 v[230:231], v248 offset:384
  ds_read_b128 v[220:223], v253 offset:576
  v_mfma_f32_16x16x32_bf16 v[28:31], v[172:175], v[84:87], v[28:31]
  v_cvt_pk_bf16_f32 v182, v164, v165
  ds_read_b64 v[232:233], v248 offset:512
  v_mfma_f32_16x16x32_bf16 v[20:23], v[172:175], v[80:83], v[20:23]
  v_cvt_pk_bf16_f32 v183, v166, v167
  ds_read_b64 v[234:235], v248 offset:640
  v_mfma_f32_16x16x32_bf16 v[12:15], v[172:175], v[76:79], v[12:15]
  ds_read_b64 v[236:237], v248 offset:768
  v_mfma_f32_16x16x32_bf16 v[4:7], v[172:175], v[72:75], v[4:7]
  ds_read_b64 v[238:239], v248 offset:896
  s_waitcnt lgkmcnt(0)
  v_mfma_f32_16x16x32_bf16 v[0:3], v[176:179], v[104:107], v[0:3]
  v_mfma_f32_16x16x32_bf16 v[4:7], v[180:183], v[104:107], v[4:7]
  v_mfma_f32_16x16x32_bf16 v[8:11], v[176:179], v[108:111], v[8:11]
  v_mfma_f32_16x16x32_bf16 v[12:15], v[180:183], v[108:111], v[12:15]
  v_mfma_f32_16x16x32_bf16 v[16:19], v[176:179], v[112:115], v[16:19]
  v_mfma_f32_16x16x32_bf16 v[20:23], v[180:183], v[112:115], v[20:23]
  v_fma_f32 v240, v208, v225, v216
  v_fma_f32 v241, v209, v225, v217
  v_fma_f32 v242, v210, v225, v218
  v_fma_f32 v243, v211, v225, v219
  v_fma_f32 v244, v212, v225, v220
  v_fma_f32 v245, v213, v225, v221
  v_fma_f32 v246, v214, v225, v222
  v_fma_f32 v247, v215, v225, v223
  v_fma_f32 v0, v0, v224, v240
  v_fma_f32 v1, v1, v224, v241
  v_fma_f32 v2, v2, v224, v242
  v_fma_f32 v3, v3, v224, v243
  v_fma_f32 v4, v4, v224, v244
  v_fma_f32 v5, v5, v224, v245
  v_fma_f32 v6, v6, v224, v246
  v_fma_f32 v7, v7, v224, v247
  v_cvt_pk_bf16_f32 v152, v0, v1
  v_cvt_pk_bf16_f32 v153, v2, v3
  v_cvt_pk_bf16_f32 v154, v4, v5
  v_cvt_pk_bf16_f32 v155, v6, v7
  s_mov_b32 s33, 0
  s_nop 0
  v_permlane16_swap_b32 v152, v154
  v_permlane16_swap_b32 v153, v155
  buffer_store_dwordx4 v[152:155], v249, s[28:31], s33 offen sc0 sc1
  v_mfma_f32_16x16x32_bf16 v[24:27], v[176:179], v[116:119], v[24:27]
  v_mfma_f32_16x16x32_bf16 v[28:31], v[180:183], v[116:119], v[28:31]
  v_fma_f32 v240, v208, v227, v216
  v_fma_f32 v241, v209, v227, v217
  v_fma_f32 v242, v210, v227, v218
  v_fma_f32 v243, v211, v227, v219
  v_fma_f32 v244, v212, v227, v220
  v_fma_f32 v245, v213, v227, v221
  v_fma_f32 v246, v214, v227, v222
  v_fma_f32 v247, v215, v227, v223
  v_fma_f32 v8, v8, v226, v240
  v_fma_f32 v9, v9, v226, v241
  v_fma_f32 v10, v10, v226, v242
  v_fma_f32 v11, v11, v226, v243
  v_fma_f32 v12, v12, v226, v244
  v_fma_f32 v13, v13, v226, v245
  v_fma_f32 v14, v14, v226, v246
  v_fma_f32 v15, v15, v226, v247
  v_cvt_pk_bf16_f32 v156, v8, v9
  v_cvt_pk_bf16_f32 v157, v10, v11
  v_cvt_pk_bf16_f32 v158, v12, v13
  v_cvt_pk_bf16_f32 v159, v14, v15
  s_mov_b32 s33, 32768
  s_nop 0
  v_permlane16_swap_b32 v156, v158
  v_permlane16_swap_b32 v157, v159
  buffer_store_dwordx4 v[156:159], v249, s[28:31], s33 offen sc0 sc1
  v_mfma_f32_16x16x32_bf16 v[32:35], v[176:179], v[120:123], v[32:35]
  v_mfma_f32_16x16x32_bf16 v[36:39], v[180:183], v[120:123], v[36:39]
  v_fma_f32 v240, v208, v229, v216
  v_fma_f32 v241, v209, v229, v217
  v_fma_f32 v242, v210, v229, v218
  v_fma_f32 v243, v211, v229, v219
  v_fma_f32 v244, v212, v229, v220
  v_fma_f32 v245, v213, v229, v221
  v_fma_f32 v246, v214, v229, v222
  v_fma_f32 v247, v215, v229, v223
  v_fma_f32 v16, v16, v228, v240
  v_fma_f32 v17, v17, v228, v241
  v_fma_f32 v18, v18, v228, v242
  v_fma_f32 v19, v19, v228, v243
  v_fma_f32 v20, v20, v228, v244
  v_fma_f32 v21, v21, v228, v245
  v_fma_f32 v22, v22, v228, v246
  v_fma_f32 v23, v23, v228, v247
  v_cvt_pk_bf16_f32 v160, v16, v17
  v_cvt_pk_bf16_f32 v161, v18, v19
  v_cvt_pk_bf16_f32 v162, v20, v21
  v_cvt_pk_bf16_f32 v163, v22, v23
  s_mov_b32 s33, 65536
  s_nop 0
  v_permlane16_swap_b32 v160, v162
  v_permlane16_swap_b32 v161, v163
  buffer_store_dwordx4 v[160:163], v249, s[28:31], s33 offen sc0 sc1
  v_mfma_f32_16x16x32_bf16 v[40:43], v[176:179], v[124:127], v[40:43]
  v_mfma_f32_16x16x32_bf16 v[44:47], v[180:183], v[124:127], v[44:47]
  v_fma_f32 v240, v208, v231, v216
  v_fma_f32 v241, v209, v231, v217
  v_fma_f32 v242, v210, v231, v218
  v_fma_f32 v243, v211, v231, v219
  v_fma_f32 v244, v212, v231, v220
  v_fma_f32 v245, v213, v231, v221
  v_fma_f32 v246, v214, v231, v222
  v_fma_f32 v247, v215, v231, v223
  v_fma_f32 v24, v24, v230, v240
  v_fma_f32 v25, v25, v230, v241
  v_fma_f32 v26, v26, v230, v242
  v_fma_f32 v27, v27, v230, v243
  v_fma_f32 v28, v28, v230, v244
  v_fma_f32 v29, v29, v230, v245
  v_fma_f32 v30, v30, v230, v246
  v_fma_f32 v31, v31, v230, v247
  v_cvt_pk_bf16_f32 v164, v24, v25
  v_cvt_pk_bf16_f32 v165, v26, v27
  v_cvt_pk_bf16_f32 v166, v28, v29
  v_cvt_pk_bf16_f32 v167, v30, v31
  s_mov_b32 s33, 98304
  s_nop 0
  v_permlane16_swap_b32 v164, v166
  v_permlane16_swap_b32 v165, v167
  buffer_store_dwordx4 v[164:167], v249, s[28:31], s33 offen sc0 sc1
  v_mfma_f32_16x16x32_bf16 v[48:51], v[176:179], v[128:131], v[48:51]
  v_mfma_f32_16x16x32_bf16 v[52:55], v[180:183], v[128:131], v[52:55]
  v_fma_f32 v240, v208, v233, v216
  v_fma_f32 v241, v209, v233, v217
  v_fma_f32 v242, v210, v233, v218
  v_fma_f32 v243, v211, v233, v219
  v_fma_f32 v244, v212, v233, v220
  v_fma_f32 v245, v213, v233, v221
  v_fma_f32 v246, v214, v233, v222
  v_fma_f32 v247, v215, v233, v223
  v_fma_f32 v32, v32, v232, v240
  v_fma_f32 v33, v33, v232, v241
  v_fma_f32 v34, v34, v232, v242
  v_fma_f32 v35, v35, v232, v243
  v_fma_f32 v36, v36, v232, v244
  v_fma_f32 v37, v37, v232, v245
  v_fma_f32 v38, v38, v232, v246
  v_fma_f32 v39, v39, v232, v247
  v_cvt_pk_bf16_f32 v152, v32, v33
  v_cvt_pk_bf16_f32 v153, v34, v35
  v_cvt_pk_bf16_f32 v154, v36, v37
  v_cvt_pk_bf16_f32 v155, v38, v39
  s_mov_b32 s33, 131072
  s_nop 0
  v_permlane16_swap_b32 v152, v154
  v_permlane16_swap_b32 v153, v155
  buffer_store_dwordx4 v[152:155], v249, s[28:31], s33 offen sc0 sc1
  v_mfma_f32_16x16x32_bf16 v[56:59], v[176:179], v[132:135], v[56:59]
  v_mfma_f32_16x16x32_bf16 v[60:63], v[180:183], v[132:135], v[60:63]
  v_fma_f32 v240, v208, v235, v216
  v_fma_f32 v241, v209, v235, v217
  v_fma_f32 v242, v210, v235, v218
  v_fma_f32 v243, v211, v235, v219
  v_fma_f32 v244, v212, v235, v220
  v_fma_f32 v245, v213, v235, v221
  v_fma_f32 v246, v214, v235, v222
  v_fma_f32 v247, v215, v235, v223
  v_fma_f32 v40, v40, v234, v240
  v_fma_f32 v41, v41, v234, v241
  v_fma_f32 v42, v42, v234, v242
  v_fma_f32 v43, v43, v234, v243
  v_fma_f32 v44, v44, v234, v244
  v_fma_f32 v45, v45, v234, v245
  v_fma_f32 v46, v46, v234, v246
  v_fma_f32 v47, v47, v234, v247
  v_cvt_pk_bf16_f32 v156, v40, v41
  v_cvt_pk_bf16_f32 v157, v42, v43
  v_cvt_pk_bf16_f32 v158, v44, v45
  v_cvt_pk_bf16_f32 v159, v46, v47
  s_mov_b32 s33, 163840
  s_nop 0
  v_permlane16_swap_b32 v156, v158
  v_permlane16_swap_b32 v157, v159
  buffer_store_dwordx4 v[156:159], v249, s[28:31], s33 offen sc0 sc1
  v_fma_f32 v240, v208, v237, v216
  v_fma_f32 v241, v209, v237, v217
  v_fma_f32 v242, v210, v237, v218
  v_fma_f32 v243, v211, v237, v219
  v_fma_f32 v244, v212, v237, v220
  v_fma_f32 v245, v213, v237, v221
  v_fma_f32 v246, v214, v237, v222
  v_fma_f32 v247, v215, v237, v223
  v_fma_f32 v48, v48, v236, v240
  v_fma_f32 v49, v49, v236, v241
  v_fma_f32 v50, v50, v236, v242
  v_fma_f32 v51, v51, v236, v243
  v_fma_f32 v52, v52, v236, v244
  v_fma_f32 v53, v53, v236, v245
  v_fma_f32 v54, v54, v236, v246
  v_fma_f32 v55, v55, v236, v247
  v_cvt_pk_bf16_f32 v160, v48, v49
  v_cvt_pk_bf16_f32 v161, v50, v51
  v_cvt_pk_bf16_f32 v162, v52, v53
  v_cvt_pk_bf16_f32 v163, v54, v55
  s_mov_b32 s33, 196608
  s_nop 0
  v_permlane16_swap_b32 v160, v162
  v_permlane16_swap_b32 v161, v163
  buffer_store_dwordx4 v[160:163], v249, s[28:31], s33 offen sc0 sc1
  v_fma_f32 v240, v208, v239, v216
  v_fma_f32 v241, v209, v239, v217
  v_fma_f32 v242, v210, v239, v218
  v_fma_f32 v243, v211, v239, v219
  v_fma_f32 v244, v212, v239, v220
  v_fma_f32 v245, v213, v239, v221
  v_fma_f32 v246, v214, v239, v222
  v_fma_f32 v247, v215, v239, v223
  v_fma_f32 v56, v56, v238, v240
  v_fma_f32 v57, v57, v238, v241
  v_fma_f32 v58, v58, v238, v242
  v_fma_f32 v59, v59, v238, v243
  v_fma_f32 v60, v60, v238, v244
  v_fma_f32 v61, v61, v238, v245
  v_fma_f32 v62, v62, v238, v246
  v_fma_f32 v63, v63, v238, v247
  v_cvt_pk_bf16_f32 v164, v56, v57
  v_cvt_pk_bf16_f32 v165, v58, v59
  v_cvt_pk_bf16_f32 v166, v60, v61
  v_cvt_pk_bf16_f32 v167, v62, v63
  s_mov_b32 s33, 229376
  s_nop 0
  v_permlane16_swap_b32 v164, v166
  v_permlane16_swap_b32 v165, v167
  buffer_store_dwordx4 v[164:167], v249, s[28:31], s33 offen sc0 sc1
G_done:
  s_endpgm
L_end:
.section .rodata,"a"
.p2align 6
.amdhsa_kernel standalone__layernorm_linear__prompt_kernel
  .amdhsa_next_free_vgpr 256
  .amdhsa_next_free_sgpr 100
  .amdhsa_accum_offset 256
  .amdhsa_group_segment_fixed_size 0
  .amdhsa_kernarg_size 56
  .amdhsa_user_sgpr_count 2
  .amdhsa_user_sgpr_kernarg_segment_ptr 1
  .amdhsa_system_sgpr_workgroup_id_x 1
  .amdhsa_float_denorm_mode_32 3
.end_amdhsa_kernel
.text
```
